```python
import torch

def _softmax(x, axis=-1):
    return torch.softmax(x, dim=axis)
def _gelu(x):
    return torch.nn.functional.gelu(x, approximate="tanh")
def _silu(x):
    return torch.nn.functional.silu(x)
def _sigmoid(x):
    return torch.sigmoid(x)
def _layernorm(x, axis=-1, eps=1e-5):
    m = x.mean(dim=axis, keepdim=True)
    v = x.var(dim=axis, keepdim=True, unbiased=False)
    return (x - m) / torch.sqrt(v + eps)
def _scatter_add(tgt, idx, src, axis=0):
    return tgt.clone().index_add_(axis, idx, src)
def _segment_sum(src, seg, n):
    out = torch.zeros((n,) + src.shape[1:], dtype=src.dtype)
    return out.index_add_(0, seg, src)
def _pad(x, pw):
    flat = tuple(v for pair in reversed(pw) for v in pair)
    return torch.nn.functional.pad(x, flat)

kernel_name = 'gated_mix__softmax_full_mha__dense_activation_squared_relu__prompt'

def setup_inputs():

    _w = (lambda a: (lambda t: t.to(torch.bfloat16) if t.is_floating_point() else t)(torch.as_tensor(a)))
    def _A_setup():
        B, S, D = 1, 2048, 640
        return {
            "x": _w((lambda *s: torch.randn(*s, dtype=torch.bfloat16) * 0.05)(B, S, D)),
            "wqkv": _w((lambda *s: torch.randn(*s, dtype=torch.bfloat16) * 0.8)(D, 3 * D)),
            "wo": _w((lambda *s: torch.randn(*s, dtype=torch.bfloat16) * 0.1)(D, D)),
        }
    _A_in = _A_setup()

    def _B_setup():
        B, S, D, F = 1, 2048, 640, 1536
        return {
            "x": _w((lambda *s: torch.randn(*s, dtype=torch.bfloat16) * 0.05)(B, S, D)),
            "w1": _w((lambda *s: torch.randn(*s, dtype=torch.bfloat16) * 0.1)(D, F)),
            "b1": _w((lambda *s: torch.randn(*s, dtype=torch.bfloat16) * 0.1)(F)),
            "w2": _w((lambda *s: torch.randn(*s, dtype=torch.bfloat16) * 0.1)(F, D)),
            "b2": _w((lambda *s: torch.randn(*s, dtype=torch.bfloat16) * 0.05)(D)),
        }
    _B_in = _B_setup()

    return {
        "A_x": _A_in["x"],
        "A_wqkv": _A_in["wqkv"],
        "A_wo": _A_in["wo"],
        "B_x": _B_in["x"],
        "B_w1": _B_in["w1"],
        "B_b1": _B_in["b1"],
        "B_w2": _B_in["w2"],
        "B_b2": _B_in["b2"],
        "gate_w": _w((lambda *s: torch.randn(*s, dtype=torch.bfloat16) * 0.05)(640) * 16.0),
    }

def reference(A_x, A_wqkv, A_wo, B_x, B_w1, B_b1, B_w2, B_b2, gate_w):
    def _A_ref(x, wqkv, wo):
        B, S, D = x.shape
        H = 32; Dh = D // H
        qkv = (lambda x, *d: x.permute(*d))((x @ wqkv).reshape(B, S, 3, H, Dh), 2, 0, 3, 1, 4)
        q, k, v = qkv[0], qkv[1], qkv[2]
        scale = Dh ** -0.5
        scores = torch.einsum("bhqd,bhkd->bhqk", q, k) * scale
        p = _softmax(scores, axis=-1)
        o = torch.einsum("bhqk,bhkd->bhqd", p, v)
        return (lambda x, *d: x.permute(*d))(o, 0, 2, 1, 3).reshape(B, S, D) @ wo

    def _B_ref(x, w1, b1, w2, b2):
        h = torch.einsum("bsd,df->bsf", x, w1) + b1
        zero = torch.zeros_like(h)
        r = torch.where(h > zero, h, zero)
        h = r * r
        out = torch.einsum("bsf,fd->bsd", h, w2) + b2
        return out

    x = A_x
    g = _sigmoid((x * gate_w).sum(-1, keepdims=True))
    a = _A_ref(x, A_wqkv, A_wo)
    b = _B_ref(x, B_w1, B_b1, B_w2, B_b2)
    return g * a + (1 - g) * b
```

```asm
; @launch grid=(256,1,1) block=(512,1,1) lds=163840
.amdgcn_target "amdgcn-amd-amdhsa--gfx950"
.text
.globl gated_mix__softmax_full_mha__dense_activation_squared_relu__prompt_kernel
.p2align 8
.type gated_mix__softmax_full_mha__dense_activation_squared_relu__prompt_kernel,@function
gated_mix__softmax_full_mha__dense_activation_squared_relu__prompt_kernel:
    s_cmp_ge_u32 s2, 256
    s_cbranch_scc1 L_end
    s_load_dwordx16 s[28:43], s[0:1], 0
    s_load_dwordx8 s[44:51], s[0:1], 64
    v_lshrrev_b32 v1, 6, v0
    v_and_b32 v0, 63, v0
    v_readfirstlane_b32 s52, v1
    s_and_b32 s60, s2, 7
    s_bfe_u32 s61, s2, 0x30003
    s_lshr_b32 s62, s2, 6
    s_lshr_b32 s53, s60, 2
    s_lshl_b32 s53, s53, 3
    s_add_u32 s53, s53, s61
    s_and_b32 s54, s60, 3
    s_lshl_b32 s54, s54, 2
    s_add_u32 s54, s54, s62
    s_mul_i32 s60, s60, 2
    s_add_u32 s61, s61, s60
    s_add_u32 s63, s61, 4
    s_add_u32 s61, s61, s62
    s_mul_i32 s60, s61, 205
    s_lshr_b32 s60, s60, 10
    s_mul_i32 s60, s60, 5
    s_sub_u32 s69, s61, s60
    s_lshl_b32 s69, s69, 1
    s_cmp_lg_u32 s62, 3
    s_cselect_b32 s94, 1, 0
    s_cmp_lt_u32 s54, 14
    s_cselect_b32 s94, s94, 0
    s_lshr_b32 s60, s54, 2
    s_sub_u32 s95, s54, s60
    s_add_u32 s95, s95, 1
    s_lshl_b32 s95, s95, 7
    s_lshl_b32 s56, s54, 7
    s_cmp_ge_u32 s54, 10
    s_cselect_b32 s55, 2, 0
    s_cmp_eq_u32 s54, 15
    s_cselect_b32 s55, 1, s55
    s_cselect_b32 s56, 0, s56
    s_cselect_b32 s95, 0, s95
    s_and_b32 s57, s2, 7
    s_lshl_b32 s57, s57, 2
    s_bfe_u32 s60, s2, 0x20003
    s_add_u32 s57, s57, s60
    s_lshr_b32 s96, s2, 5
    s_lshr_b32 s60, s57, 3
    s_lshl_b32 s87, s96, 2
    s_add_u32 s87, s87, s60
    s_lshl_b32 s87, s87, 6
    s_and_b32 s88, s57, 7
    s_mul_i32 s88, s88, 5
    s_waitcnt lgkmcnt(0)
    s_mov_b32 s4, s28
    s_mov_b32 s5, s29
    s_mov_b32 s6, 2621440
    s_mov_b32 s7, 0x00020000
    s_mov_b32 s12, s50
    s_mov_b32 s13, s51
    s_mov_b32 s14, 19884032
    s_mov_b32 s15, 0x00020000
    s_mov_b32 s24, s48
    s_mov_b32 s25, s49
    s_mov_b32 s26, 8
    s_mov_b32 s27, 0x00020000
    s_cmp_lt_u32 s52, 4
    s_cbranch_scc1 L_A
    s_setprio 3
    s_sub_u32 s75, s52, 4
    s_or_b32 s60, s2, s75
    s_cmp_lg_u32 s60, 0
    s_cbranch_scc1 LH_noep
    s_memrealtime s[80:81]
    s_waitcnt lgkmcnt(0)
    s_or_b32 s80, s80, 1
    v_mov_b32 v22, s80
    v_mov_b32 v23, s81
    v_lshlrev_b32 v24, 3, v0
    buffer_store_dwordx2 v[22:23], v24, s[24:27], 0 offen sc1
LH_noep:
    v_lshrrev_b32 v10, 3, v0
    v_and_b32 v11, 7, v0
    s_cmp_eq_u32 s55, 0
    s_cselect_b32 s60, 2, 1
    s_mul_i32 s61, s60, 1280
    v_mul_u32_u24 v2, s61, v10
    v_xor_b32 v16, v10, v11
    v_lshl_add_u32 v2, v16, 4, v2
    s_lshl_b32 s62, s53, 7
    s_lshl_b32 s63, s75, 5
    s_add_u32 s62, s62, s63
    s_mul_i32 s70, s62, 1280
    s_lshl_b32 s61, s61, 3
    s_add_u32 s71, s70, s61
    s_cmp_eq_u32 s55, 0
    s_cselect_b32 s60, 1, 16
    s_mul_i32 s60, s60, 1280
    s_add_u32 s72, s70, s60
    s_add_u32 s73, s71, s60
    s_lshl_b32 s78, s75, 12
    s_add_u32 s79, s78, 0x4000
    s_mov_b32 s59, s69
    s_lshl_b32 s62, s59, 7
    s_add_u32 m0, s78, 0
    s_add_u32 s64, s70, s62
    buffer_load_dwordx4 v2, s[4:7], s64 offen lds
    s_add_u32 m0, s78, 1024
    s_add_u32 s64, s71, s62
    buffer_load_dwordx4 v2, s[4:7], s64 offen lds
    s_add_u32 m0, s78, 2048
    s_add_u32 s64, s72, s62
    buffer_load_dwordx4 v2, s[4:7], s64 offen lds
    s_add_u32 m0, s78, 3072
    s_add_u32 s64, s73, s62
    buffer_load_dwordx4 v2, s[4:7], s64 offen lds
    v_lshrrev_b32 v12, 4, v0
    v_bfe_u32 v16, v0, 1, 3
    v_xor_b32 v13, v16, v12
    v_xor_b32 v14, 4, v13
    v_and_b32 v16, 1, v0
    v_lshlrev_b32 v16, 4, v16
    v_lshl_add_u32 v13, v13, 5, v16
    v_lshl_add_u32 v14, v14, 5, v16
    v_lshlrev_b32 v5, 4, v0
    v_add_u32 v30, s78, v5
    v_add_u32 v31, 0x10000, v30
    s_cmp_eq_u32 s55, 1
    s_cbranch_scc1 LH_j15
    s_mov_b32 s8, s30
    s_mov_b32 s9, s31
    s_mov_b32 s10, 2457600
    s_mov_b32 s11, 0x00020000
    s_mov_b32 s68, 15360
    v_mul_u32_u24 v3, 3840, v12
    v_add_u32 v4, v3, v14
    v_add_u32 v3, v3, v13
    s_mul_i32 s74, s75, 61440
    s_lshl_b32 s62, s56, 1
    s_add_u32 s74, s74, s62
    s_mov_b32 s59, s69
    s_branch LH_go
LH_j15:
    s_mov_b32 s8, s36
    s_mov_b32 s9, s37
    s_mov_b32 s10, 1966080
    s_mov_b32 s11, 0x00020000
    s_mov_b32 s68, 12288
    v_mul_u32_u24 v3, 3072, v12
    v_add_u32 v4, v3, v14
    v_add_u32 v3, v3, v13
    s_mul_i32 s74, s75, 49152
    s_lshl_b32 s62, s56, 1
    s_add_u32 s74, s74, s62
    s_mov_b32 s59, s69
LH_go:
    s_lshl_b32 s63, s59, 4
    s_mul_i32 s63, s63, s68
    s_add_u32 s63, s63, s74
    s_add_u32 m0, s79, 0
    s_nop 0
    buffer_load_dwordx4 v3, s[8:11], s63 offen lds
    s_add_u32 s63, s63, s68
    s_add_u32 m0, s79, 1024
    s_nop 0
    buffer_load_dwordx4 v3, s[8:11], s63 offen lds
    s_add_u32 s63, s63, s68
    s_add_u32 m0, s79, 2048
    s_nop 0
    buffer_load_dwordx4 v4, s[8:11], s63 offen lds
    s_add_u32 s63, s63, s68
    s_add_u32 m0, s79, 3072
    s_nop 0
    buffer_load_dwordx4 v4, s[8:11], s63 offen lds
    s_add_u32 s59, s59, 1
    s_cmp_eq_u32 s59, 10
    s_cselect_b32 s59, 0, s59
    s_lshl_b32 s62, s59, 7
    s_add_u32 m0, s78, 32768
    s_add_u32 s64, s70, s62
    buffer_load_dwordx4 v2, s[4:7], s64 offen lds
    s_add_u32 m0, s78, 33792
    s_add_u32 s64, s71, s62
    buffer_load_dwordx4 v2, s[4:7], s64 offen lds
    s_add_u32 m0, s78, 34816
    s_add_u32 s64, s72, s62
    buffer_load_dwordx4 v2, s[4:7], s64 offen lds
    s_add_u32 m0, s78, 35840
    s_add_u32 s64, s73, s62
    buffer_load_dwordx4 v2, s[4:7], s64 offen lds
    s_lshl_b32 s63, s59, 4
    s_mul_i32 s63, s63, s68
    s_add_u32 s63, s63, s74
    s_add_u32 m0, s79, 32768
    s_nop 0
    buffer_load_dwordx4 v3, s[8:11], s63 offen lds
    s_add_u32 s63, s63, s68
    s_add_u32 m0, s79, 33792
    s_nop 0
    buffer_load_dwordx4 v3, s[8:11], s63 offen lds
    s_add_u32 s63, s63, s68
    s_add_u32 m0, s79, 34816
    s_nop 0
    buffer_load_dwordx4 v4, s[8:11], s63 offen lds
    s_add_u32 s63, s63, s68
    s_add_u32 m0, s79, 35840
    s_nop 0
    buffer_load_dwordx4 v4, s[8:11], s63 offen lds
    s_add_u32 s59, s59, 1
    s_cmp_eq_u32 s59, 10
    s_cselect_b32 s59, 0, s59
    s_waitcnt vmcnt(8) lgkmcnt(0)
    s_barrier
    ds_read_b128 v[96:99], v30 offset:0
    ds_read_b128 v[100:103], v30 offset:1024
    ds_read_b128 v[104:107], v30 offset:2048
    ds_read_b128 v[108:111], v30 offset:3072
    s_lshl_b32 s62, s59, 7
    s_add_u32 m0, s78, 65536
    s_add_u32 s64, s70, s62
    buffer_load_dwordx4 v2, s[4:7], s64 offen lds
    s_add_u32 m0, s78, 66560
    s_add_u32 s64, s71, s62
    buffer_load_dwordx4 v2, s[4:7], s64 offen lds
    s_add_u32 m0, s78, 67584
    s_add_u32 s64, s72, s62
    buffer_load_dwordx4 v2, s[4:7], s64 offen lds
    s_add_u32 m0, s78, 68608
    s_add_u32 s64, s73, s62
    buffer_load_dwordx4 v2, s[4:7], s64 offen lds
    s_lshl_b32 s63, s59, 4
    s_mul_i32 s63, s63, s68
    s_add_u32 s63, s63, s74
    s_add_u32 m0, s79, 65536
    s_nop 0
    buffer_load_dwordx4 v3, s[8:11], s63 offen lds
    s_add_u32 s63, s63, s68
    s_add_u32 m0, s79, 66560
    s_nop 0
    buffer_load_dwordx4 v3, s[8:11], s63 offen lds
    s_add_u32 s63, s63, s68
    s_add_u32 m0, s79, 67584
    s_nop 0
    buffer_load_dwordx4 v4, s[8:11], s63 offen lds
    s_add_u32 s63, s63, s68
    s_add_u32 m0, s79, 68608
    s_nop 0
    buffer_load_dwordx4 v4, s[8:11], s63 offen lds
    s_add_u32 s59, s59, 1
    s_cmp_eq_u32 s59, 10
    s_cselect_b32 s59, 0, s59
    s_lshl_b32 s62, s59, 7
    s_add_u32 m0, s78, 98304
    s_add_u32 s64, s70, s62
    buffer_load_dwordx4 v2, s[4:7], s64 offen lds
    s_add_u32 m0, s78, 99328
    s_add_u32 s64, s71, s62
    buffer_load_dwordx4 v2, s[4:7], s64 offen lds
    s_add_u32 m0, s78, 100352
    s_add_u32 s64, s72, s62
    buffer_load_dwordx4 v2, s[4:7], s64 offen lds
    s_add_u32 m0, s78, 101376
    s_add_u32 s64, s73, s62
    buffer_load_dwordx4 v2, s[4:7], s64 offen lds
    s_lshl_b32 s63, s59, 4
    s_mul_i32 s63, s63, s68
    s_add_u32 s63, s63, s74
    s_add_u32 m0, s79, 98304
    s_nop 0
    buffer_load_dwordx4 v3, s[8:11], s63 offen lds
    s_add_u32 s63, s63, s68
    s_add_u32 m0, s79, 99328
    s_nop 0
    buffer_load_dwordx4 v3, s[8:11], s63 offen lds
    s_add_u32 s63, s63, s68
    s_add_u32 m0, s79, 100352
    s_nop 0
    buffer_load_dwordx4 v4, s[8:11], s63 offen lds
    s_add_u32 s63, s63, s68
    s_add_u32 m0, s79, 101376
    s_nop 0
    buffer_load_dwordx4 v4, s[8:11], s63 offen lds
    s_add_u32 s59, s59, 1
    s_cmp_eq_u32 s59, 10
    s_cselect_b32 s59, 0, s59
    s_waitcnt vmcnt(16) lgkmcnt(0)
    s_barrier
    ds_read_b128 v[112:115], v30 offset:32768
    ds_read_b128 v[116:119], v30 offset:33792
    ds_read_b128 v[120:123], v30 offset:34816
    ds_read_b128 v[124:127], v30 offset:35840
    s_lshl_b32 s62, s59, 7
    s_add_u32 m0, s78, 0
    s_add_u32 s64, s70, s62
    buffer_load_dwordx4 v2, s[4:7], s64 offen lds
    s_add_u32 m0, s78, 1024
    s_add_u32 s64, s71, s62
    buffer_load_dwordx4 v2, s[4:7], s64 offen lds
    s_add_u32 m0, s78, 2048
    s_add_u32 s64, s72, s62
    buffer_load_dwordx4 v2, s[4:7], s64 offen lds
    s_add_u32 m0, s78, 3072
    s_add_u32 s64, s73, s62
    buffer_load_dwordx4 v2, s[4:7], s64 offen lds
    s_lshl_b32 s63, s59, 4
    s_mul_i32 s63, s63, s68
    s_add_u32 s63, s63, s74
    s_add_u32 m0, s79, 0
    s_nop 0
    buffer_load_dwordx4 v3, s[8:11], s63 offen lds
    s_add_u32 s63, s63, s68
    s_add_u32 m0, s79, 1024
    s_nop 0
    buffer_load_dwordx4 v3, s[8:11], s63 offen lds
    s_add_u32 s63, s63, s68
    s_add_u32 m0, s79, 2048
    s_nop 0
    buffer_load_dwordx4 v4, s[8:11], s63 offen lds
    s_add_u32 s63, s63, s68
    s_add_u32 m0, s79, 3072
    s_nop 0
    buffer_load_dwordx4 v4, s[8:11], s63 offen lds
    s_add_u32 s59, s59, 1
    s_cmp_eq_u32 s59, 10
    s_cselect_b32 s59, 0, s59
    s_waitcnt vmcnt(16) lgkmcnt(0)
    s_barrier
    ds_read_b128 v[128:131], v31 offset:0
    ds_read_b128 v[132:135], v31 offset:1024
    ds_read_b128 v[136:139], v31 offset:2048
    ds_read_b128 v[140:143], v31 offset:3072
    s_lshl_b32 s62, s59, 7
    s_add_u32 m0, s78, 32768
    s_add_u32 s64, s70, s62
    buffer_load_dwordx4 v2, s[4:7], s64 offen lds
    s_add_u32 m0, s78, 33792
    s_add_u32 s64, s71, s62
    buffer_load_dwordx4 v2, s[4:7], s64 offen lds
    s_add_u32 m0, s78, 34816
    s_add_u32 s64, s72, s62
    buffer_load_dwordx4 v2, s[4:7], s64 offen lds
    s_add_u32 m0, s78, 35840
    s_add_u32 s64, s73, s62
    buffer_load_dwordx4 v2, s[4:7], s64 offen lds
    s_lshl_b32 s63, s59, 4
    s_mul_i32 s63, s63, s68
    s_add_u32 s63, s63, s74
    s_add_u32 m0, s79, 32768
    s_nop 0
    buffer_load_dwordx4 v3, s[8:11], s63 offen lds
    s_add_u32 s63, s63, s68
    s_add_u32 m0, s79, 33792
    s_nop 0
    buffer_load_dwordx4 v3, s[8:11], s63 offen lds
    s_add_u32 s63, s63, s68
    s_add_u32 m0, s79, 34816
    s_nop 0
    buffer_load_dwordx4 v4, s[8:11], s63 offen lds
    s_add_u32 s63, s63, s68
    s_add_u32 m0, s79, 35840
    s_nop 0
    buffer_load_dwordx4 v4, s[8:11], s63 offen lds
    s_add_u32 s59, s59, 1
    s_cmp_eq_u32 s59, 10
    s_cselect_b32 s59, 0, s59
    s_cmp_eq_u32 s55, 0
    s_cbranch_scc1 LH_perm
    s_add_u32 s62, s78, 0x10000
    v_add_u32 v16, 0, v5
    v_add_u32 v26, s62, v16
    v_add_u32 v16, 1024, v5
    v_add_u32 v27, s62, v16
    v_add_u32 v16, 2048, v5
    v_add_u32 v28, s62, v16
    v_add_u32 v16, 3072, v5
    v_add_u32 v29, s62, v16
    s_branch LH_go2
LH_perm:
    s_add_u32 s62, s78, 0x10000
    v_lshlrev_b32 v16, 1, v10
    v_add_u32 v16, 0, v16
    v_xor_b32 v17, v10, v11
    v_xor_b32 v17, v17, v16
    v_and_b32 v17, 7, v17
    v_lshlrev_b32 v17, 4, v17
    v_lshl_add_u32 v17, v16, 7, v17
    v_add_u32 v26, s62, v17
    v_lshlrev_b32 v16, 1, v10
    v_add_u32 v16, 16, v16
    v_xor_b32 v17, v10, v11
    v_xor_b32 v17, v17, v16
    v_and_b32 v17, 7, v17
    v_lshlrev_b32 v17, 4, v17
    v_lshl_add_u32 v17, v16, 7, v17
    v_add_u32 v27, s62, v17
    v_lshlrev_b32 v16, 1, v10
    v_add_u32 v16, 1, v16
    v_xor_b32 v17, v10, v11
    v_xor_b32 v17, v17, v16
    v_and_b32 v17, 7, v17
    v_lshlrev_b32 v17, 4, v17
    v_lshl_add_u32 v17, v16, 7, v17
    v_add_u32 v28, s62, v17
    v_lshlrev_b32 v16, 1, v10
    v_add_u32 v16, 17, v16
    v_xor_b32 v17, v10, v11
    v_xor_b32 v17, v17, v16
    v_and_b32 v17, 7, v17
    v_lshlrev_b32 v17, 4, v17
    v_lshl_add_u32 v17, v16, 7, v17
    v_add_u32 v29, s62, v17
LH_go2:
    s_waitcnt vmcnt(16) lgkmcnt(0)
    s_barrier
    ds_read_b128 v[144:147], v31 offset:32768
    ds_read_b128 v[148:151], v31 offset:33792
    ds_read_b128 v[152:155], v31 offset:34816
    ds_read_b128 v[156:159], v31 offset:35840
    s_lshl_b32 s62, s59, 7
    s_add_u32 m0, s78, 65536
    s_add_u32 s64, s70, s62
    buffer_load_dwordx4 v2, s[4:7], s64 offen lds
    s_add_u32 m0, s78, 66560
    s_add_u32 s64, s71, s62
    buffer_load_dwordx4 v2, s[4:7], s64 offen lds
    s_add_u32 m0, s78, 67584
    s_add_u32 s64, s72, s62
    buffer_load_dwordx4 v2, s[4:7], s64 offen lds
    s_add_u32 m0, s78, 68608
    s_add_u32 s64, s73, s62
    buffer_load_dwordx4 v2, s[4:7], s64 offen lds
    s_lshl_b32 s63, s59, 4
    s_mul_i32 s63, s63, s68
    s_add_u32 s63, s63, s74
    s_add_u32 m0, s79, 65536
    s_nop 0
    buffer_load_dwordx4 v3, s[8:11], s63 offen lds
    s_add_u32 s63, s63, s68
    s_add_u32 m0, s79, 66560
    s_nop 0
    buffer_load_dwordx4 v3, s[8:11], s63 offen lds
    s_add_u32 s63, s63, s68
    s_add_u32 m0, s79, 67584
    s_nop 0
    buffer_load_dwordx4 v4, s[8:11], s63 offen lds
    s_add_u32 s63, s63, s68
    s_add_u32 m0, s79, 68608
    s_nop 0
    buffer_load_dwordx4 v4, s[8:11], s63 offen lds
    s_add_u32 s59, s59, 1
    s_cmp_eq_u32 s59, 10
    s_cselect_b32 s59, 0, s59
    v_mov_b32 v24, 0
    buffer_load_dwordx2 v[22:23], v24, s[24:27], 0 offen sc1
    s_waitcnt vmcnt(17) lgkmcnt(0)
    s_barrier
    ds_read_b128 v[160:163], v30 offset:0
    ds_read_b128 v[164:167], v30 offset:1024
    ds_read_b128 v[168:171], v30 offset:2048
    ds_read_b128 v[172:175], v30 offset:3072
    s_lshl_b32 s62, s59, 7
    s_add_u32 m0, s78, 98304
    s_add_u32 s64, s70, s62
    buffer_load_dwordx4 v2, s[4:7], s64 offen lds
    s_add_u32 m0, s78, 99328
    s_add_u32 s64, s71, s62
    buffer_load_dwordx4 v2, s[4:7], s64 offen lds
    s_add_u32 m0, s78, 100352
    s_add_u32 s64, s72, s62
    buffer_load_dwordx4 v2, s[4:7], s64 offen lds
    s_add_u32 m0, s78, 101376
    s_add_u32 s64, s73, s62
    buffer_load_dwordx4 v2, s[4:7], s64 offen lds
    s_lshl_b32 s63, s59, 4
    s_mul_i32 s63, s63, s68
    s_add_u32 s63, s63, s74
    s_add_u32 m0, s79, 98304
    s_nop 0
    buffer_load_dwordx4 v3, s[8:11], s63 offen lds
    s_add_u32 s63, s63, s68
    s_add_u32 m0, s79, 99328
    s_nop 0
    buffer_load_dwordx4 v3, s[8:11], s63 offen lds
    s_add_u32 s63, s63, s68
    s_add_u32 m0, s79, 100352
    s_nop 0
    buffer_load_dwordx4 v4, s[8:11], s63 offen lds
    s_add_u32 s63, s63, s68
    s_add_u32 m0, s79, 101376
    s_nop 0
    buffer_load_dwordx4 v4, s[8:11], s63 offen lds
    s_add_u32 s59, s59, 1
    s_cmp_eq_u32 s59, 10
    s_cselect_b32 s59, 0, s59
    s_mul_i32 s60, s57, 20
    s_add_u32 s61, s60, 19
    s_lshr_b32 s60, s60, 6
    s_lshr_b32 s61, s61, 6
    s_sub_u32 s61, s61, s60
    v_bfe_u32 v82, v0, 4, 1
    v_mul_u32_u24 v82, s61, v82
    v_add_u32 v82, s60, v82
    v_lshrrev_b32 v83, 1, v82
    v_lshlrev_b32 v83, 11, v83
    v_and_b32 v82, 1, v82
    v_lshl_add_u32 v83, v82, 4, v83
    s_lshl_b32 s60, s96, 8
    s_add_u32 s60, s60, 19578880
    v_add_u32 v81, s60, v83
    v_and_b32 v82, 1, v0
    v_lshl_add_u32 v81, v82, 7, v81
    v_and_b32 v82, 15, v0
    v_lshl_add_u32 v83, v82, 7, v83
    v_lshrrev_b32 v82, 5, v0
    v_mul_u32_u24 v82, 10240, v82
    v_add_u32 v83, v83, v82
    v_add_u32 v80, 19589120, v83
    s_waitcnt vmcnt(17) lgkmcnt(0)
    s_barrier
    ds_read_b128 v[176:179], v30 offset:32768
    ds_read_b128 v[180:183], v30 offset:33792
    ds_read_b128 v[184:187], v30 offset:34816
    ds_read_b128 v[188:191], v30 offset:35840
    s_lshl_b32 s62, s59, 7
    s_add_u32 m0, s78, 0
    s_add_u32 s64, s70, s62
    buffer_load_dwordx4 v2, s[4:7], s64 offen lds
    s_add_u32 m0, s78, 1024
    s_add_u32 s64, s71, s62
    buffer_load_dwordx4 v2, s[4:7], s64 offen lds
    s_add_u32 m0, s78, 2048
    s_add_u32 s64, s72, s62
    buffer_load_dwordx4 v2, s[4:7], s64 offen lds
    s_add_u32 m0, s78, 3072
    s_add_u32 s64, s73, s62
    buffer_load_dwordx4 v2, s[4:7], s64 offen lds
    s_lshl_b32 s63, s59, 4
    s_mul_i32 s63, s63, s68
    s_add_u32 s63, s63, s74
    s_add_u32 m0, s79, 0
    s_nop 0
    buffer_load_dwordx4 v3, s[8:11], s63 offen lds
    s_add_u32 s63, s63, s68
    s_add_u32 m0, s79, 1024
    s_nop 0
    buffer_load_dwordx4 v3, s[8:11], s63 offen lds
    s_add_u32 s63, s63, s68
    s_add_u32 m0, s79, 2048
    s_nop 0
    buffer_load_dwordx4 v4, s[8:11], s63 offen lds
    s_add_u32 s63, s63, s68
    s_add_u32 m0, s79, 3072
    s_nop 0
    buffer_load_dwordx4 v4, s[8:11], s63 offen lds
    s_add_u32 s59, s59, 1
    s_cmp_eq_u32 s59, 10
    s_cselect_b32 s59, 0, s59
    s_waitcnt vmcnt(17) lgkmcnt(0)
    s_barrier
    ds_read_b128 v[192:195], v31 offset:0
    ds_read_b128 v[196:199], v31 offset:1024
    ds_read_b128 v[200:203], v31 offset:2048
    ds_read_b128 v[204:207], v31 offset:3072
    s_lshl_b32 s62, s59, 7
    s_add_u32 m0, s78, 32768
    s_add_u32 s64, s70, s62
    buffer_load_dwordx4 v2, s[4:7], s64 offen lds
    s_add_u32 m0, s78, 33792
    s_add_u32 s64, s71, s62
    buffer_load_dwordx4 v2, s[4:7], s64 offen lds
    s_add_u32 m0, s78, 34816
    s_add_u32 s64, s72, s62
    buffer_load_dwordx4 v2, s[4:7], s64 offen lds
    s_add_u32 m0, s78, 35840
    s_add_u32 s64, s73, s62
    buffer_load_dwordx4 v2, s[4:7], s64 offen lds
    s_lshl_b32 s63, s59, 4
    s_mul_i32 s63, s63, s68
    s_add_u32 s63, s63, s74
    s_add_u32 m0, s79, 32768
    s_nop 0
    buffer_load_dwordx4 v3, s[8:11], s63 offen lds
    s_add_u32 s63, s63, s68
    s_add_u32 m0, s79, 33792
    s_nop 0
    buffer_load_dwordx4 v3, s[8:11], s63 offen lds
    s_add_u32 s63, s63, s68
    s_add_u32 m0, s79, 34816
    s_nop 0
    buffer_load_dwordx4 v4, s[8:11], s63 offen lds
    s_add_u32 s63, s63, s68
    s_add_u32 m0, s79, 35840
    s_nop 0
    buffer_load_dwordx4 v4, s[8:11], s63 offen lds
    s_add_u32 s59, s59, 1
    s_cmp_eq_u32 s59, 10
    s_cselect_b32 s59, 0, s59
    s_waitcnt vmcnt(24)
    s_mov_b32 s58, 0x20000
    s_branch LH_ep_c
LH_ep:
    buffer_load_dwordx2 v[22:23], v24, s[24:27], 0 offen sc1
    s_waitcnt vmcnt(0)
LH_ep_c:
    v_readfirstlane_b32 s76, v22
    v_readfirstlane_b32 s77, v23
    s_nop 0
    s_cmp_lg_u32 s76, 0
    s_cbranch_scc1 LH_ep_ok
    s_sleep 2
    s_sub_u32 s58, s58, 1
    s_cmp_lg_u32 s58, 0
    s_cbranch_scc1 LH_ep
LH_ep_ok:
    s_waitcnt vmcnt(16) lgkmcnt(0)
    s_barrier
    ds_read_b128 v[208:211], v31 offset:32768
    ds_read_b128 v[212:215], v31 offset:33792
    ds_read_b128 v[216:219], v31 offset:34816
    ds_read_b128 v[220:223], v31 offset:35840
    s_cmp_eq_u32 s94, 0
    s_cbranch_scc1 LH_short
    s_mov_b32 s8, s36
    s_mov_b32 s9, s37
    s_mov_b32 s10, 1966080
    s_mov_b32 s11, 0x00020000
    s_mov_b32 s68, 12288
    v_mul_u32_u24 v3, 3072, v12
    v_add_u32 v4, v3, v14
    v_add_u32 v3, v3, v13
    s_mul_i32 s74, s75, 49152
    s_lshl_b32 s62, s95, 1
    s_add_u32 s74, s74, s62
    s_mov_b32 s59, s69
    s_lshl_b32 s63, s59, 4
    s_mul_i32 s63, s63, s68
    s_add_u32 s63, s63, s74
    s_add_u32 m0, s79, 65536
    s_nop 0
    buffer_load_dwordx4 v3, s[8:11], s63 offen lds
    s_add_u32 s63, s63, s68
    s_add_u32 m0, s79, 66560
    s_nop 0
    buffer_load_dwordx4 v3, s[8:11], s63 offen lds
    s_add_u32 s63, s63, s68
    s_add_u32 m0, s79, 67584
    s_nop 0
    buffer_load_dwordx4 v4, s[8:11], s63 offen lds
    s_add_u32 s63, s63, s68
    s_add_u32 m0, s79, 68608
    s_nop 0
    buffer_load_dwordx4 v4, s[8:11], s63 offen lds
    s_add_u32 s59, s59, 1
    s_cmp_eq_u32 s59, 10
    s_cselect_b32 s59, 0, s59
    s_waitcnt vmcnt(12) lgkmcnt(0)
    s_barrier
    ds_read_b128 v[224:227], v30 offset:0
    ds_read_b128 v[228:231], v30 offset:1024
    ds_read_b128 v[232:235], v30 offset:2048
    ds_read_b128 v[236:239], v30 offset:3072
    s_lshl_b32 s63, s59, 4
    s_mul_i32 s63, s63, s68
    s_add_u32 s63, s63, s74
    s_add_u32 m0, s79, 98304
    s_nop 0
    buffer_load_dwordx4 v3, s[8:11], s63 offen lds
    s_add_u32 s63, s63, s68
    s_add_u32 m0, s79, 99328
    s_nop 0
    buffer_load_dwordx4 v3, s[8:11], s63 offen lds
    s_add_u32 s63, s63, s68
    s_add_u32 m0, s79, 100352
    s_nop 0
    buffer_load_dwordx4 v4, s[8:11], s63 offen lds
    s_add_u32 s63, s63, s68
    s_add_u32 m0, s79, 101376
    s_nop 0
    buffer_load_dwordx4 v4, s[8:11], s63 offen lds
    s_add_u32 s59, s59, 1
    s_cmp_eq_u32 s59, 10
    s_cselect_b32 s59, 0, s59
    s_waitcnt vmcnt(8) lgkmcnt(0)
    s_barrier
    ds_read_b128 v[240:243], v30 offset:32768
    ds_read_b128 v[244:247], v30 offset:33792
    ds_read_b128 v[248:251], v30 offset:34816
    ds_read_b128 v[252:255], v30 offset:35840
    s_waitcnt lgkmcnt(0)
    ds_write_b128 v26, v[96:99] offset:0
    ds_write_b128 v27, v[100:103] offset:0
    ds_write_b128 v28, v[104:107] offset:0
    ds_write_b128 v29, v[108:111] offset:0
    s_lshl_b32 s63, s59, 4
    s_mul_i32 s63, s63, s68
    s_add_u32 s63, s63, s74
    s_add_u32 m0, s79, 0
    s_nop 0
    buffer_load_dwordx4 v3, s[8:11], s63 offen lds
    s_add_u32 s63, s63, s68
    s_add_u32 m0, s79, 1024
    s_nop 0
    buffer_load_dwordx4 v3, s[8:11], s63 offen lds
    s_add_u32 s63, s63, s68
    s_add_u32 m0, s79, 2048
    s_nop 0
    buffer_load_dwordx4 v4, s[8:11], s63 offen lds
    s_add_u32 s63, s63, s68
    s_add_u32 m0, s79, 3072
    s_nop 0
    buffer_load_dwordx4 v4, s[8:11], s63 offen lds
    s_add_u32 s59, s59, 1
    s_cmp_eq_u32 s59, 10
    s_cselect_b32 s59, 0, s59
    s_waitcnt vmcnt(8) lgkmcnt(0)
    s_barrier
    ds_write_b128 v26, v[112:115] offset:32768
    ds_write_b128 v27, v[116:119] offset:32768
    ds_write_b128 v28, v[120:123] offset:32768
    ds_write_b128 v29, v[124:127] offset:32768
    v_xor_b32 v26, 0x10000, v26
    v_xor_b32 v27, 0x10000, v27
    v_xor_b32 v28, 0x10000, v28
    v_xor_b32 v29, 0x10000, v29
    s_lshl_b32 s63, s59, 4
    s_mul_i32 s63, s63, s68
    s_add_u32 s63, s63, s74
    s_add_u32 m0, s79, 32768
    s_nop 0
    buffer_load_dwordx4 v3, s[8:11], s63 offen lds
    s_add_u32 s63, s63, s68
    s_add_u32 m0, s79, 33792
    s_nop 0
    buffer_load_dwordx4 v3, s[8:11], s63 offen lds
    s_add_u32 s63, s63, s68
    s_add_u32 m0, s79, 34816
    s_nop 0
    buffer_load_dwordx4 v4, s[8:11], s63 offen lds
    s_add_u32 s63, s63, s68
    s_add_u32 m0, s79, 35840
    s_nop 0
    buffer_load_dwordx4 v4, s[8:11], s63 offen lds
    s_add_u32 s59, s59, 1
    s_cmp_eq_u32 s59, 10
    s_cselect_b32 s59, 0, s59
    s_waitcnt vmcnt(8) lgkmcnt(0)
    s_barrier
    ds_write_b128 v26, v[128:131] offset:0
    ds_write_b128 v27, v[132:135] offset:0
    ds_write_b128 v28, v[136:139] offset:0
    ds_write_b128 v29, v[140:143] offset:0
    s_lshl_b32 s63, s59, 4
    s_mul_i32 s63, s63, s68
    s_add_u32 s63, s63, s74
    s_add_u32 m0, s79, 65536
    s_nop 0
    buffer_load_dwordx4 v3, s[8:11], s63 offen lds
    s_add_u32 s63, s63, s68
    s_add_u32 m0, s79, 66560
    s_nop 0
    buffer_load_dwordx4 v3, s[8:11], s63 offen lds
    s_add_u32 s63, s63, s68
    s_add_u32 m0, s79, 67584
    s_nop 0
    buffer_load_dwordx4 v4, s[8:11], s63 offen lds
    s_add_u32 s63, s63, s68
    s_add_u32 m0, s79, 68608
    s_nop 0
    buffer_load_dwordx4 v4, s[8:11], s63 offen lds
    s_add_u32 s59, s59, 1
    s_cmp_eq_u32 s59, 10
    s_cselect_b32 s59, 0, s59
    s_waitcnt vmcnt(8) lgkmcnt(0)
    s_barrier
    ds_write_b128 v26, v[144:147] offset:32768
    ds_write_b128 v27, v[148:151] offset:32768
    ds_write_b128 v28, v[152:155] offset:32768
    ds_write_b128 v29, v[156:159] offset:32768
    v_xor_b32 v26, 0x10000, v26
    v_xor_b32 v27, 0x10000, v27
    v_xor_b32 v28, 0x10000, v28
    v_xor_b32 v29, 0x10000, v29
    s_lshl_b32 s63, s59, 4
    s_mul_i32 s63, s63, s68
    s_add_u32 s63, s63, s74
    s_add_u32 m0, s79, 98304
    s_nop 0
    buffer_load_dwordx4 v3, s[8:11], s63 offen lds
    s_add_u32 s63, s63, s68
    s_add_u32 m0, s79, 99328
    s_nop 0
    buffer_load_dwordx4 v3, s[8:11], s63 offen lds
    s_add_u32 s63, s63, s68
    s_add_u32 m0, s79, 100352
    s_nop 0
    buffer_load_dwordx4 v4, s[8:11], s63 offen lds
    s_add_u32 s63, s63, s68
    s_add_u32 m0, s79, 101376
    s_nop 0
    buffer_load_dwordx4 v4, s[8:11], s63 offen lds
    s_add_u32 s59, s59, 1
    s_cmp_eq_u32 s59, 10
    s_cselect_b32 s59, 0, s59
    s_waitcnt vmcnt(8) lgkmcnt(0)
    s_barrier
    ds_write_b128 v26, v[160:163] offset:0
    ds_write_b128 v27, v[164:167] offset:0
    ds_write_b128 v28, v[168:171] offset:0
    ds_write_b128 v29, v[172:175] offset:0
    s_lshl_b32 s63, s59, 4
    s_mul_i32 s63, s63, s68
    s_add_u32 s63, s63, s74
    s_add_u32 m0, s79, 0
    s_nop 0
    buffer_load_dwordx4 v3, s[8:11], s63 offen lds
    s_add_u32 s63, s63, s68
    s_add_u32 m0, s79, 1024
    s_nop 0
    buffer_load_dwordx4 v3, s[8:11], s63 offen lds
    s_add_u32 s63, s63, s68
    s_add_u32 m0, s79, 2048
    s_nop 0
    buffer_load_dwordx4 v4, s[8:11], s63 offen lds
    s_add_u32 s63, s63, s68
    s_add_u32 m0, s79, 3072
    s_nop 0
    buffer_load_dwordx4 v4, s[8:11], s63 offen lds
    s_add_u32 s59, s59, 1
    s_cmp_eq_u32 s59, 10
    s_cselect_b32 s59, 0, s59
    s_waitcnt vmcnt(8) lgkmcnt(0)
    s_barrier
    ds_write_b128 v26, v[176:179] offset:32768
    ds_write_b128 v27, v[180:183] offset:32768
    ds_write_b128 v28, v[184:187] offset:32768
    ds_write_b128 v29, v[188:191] offset:32768
    v_xor_b32 v26, 0x10000, v26
    v_xor_b32 v27, 0x10000, v27
    v_xor_b32 v28, 0x10000, v28
    v_xor_b32 v29, 0x10000, v29
    s_lshl_b32 s63, s59, 4
    s_mul_i32 s63, s63, s68
    s_add_u32 s63, s63, s74
    s_add_u32 m0, s79, 32768
    s_nop 0
    buffer_load_dwordx4 v3, s[8:11], s63 offen lds
    s_add_u32 s63, s63, s68
    s_add_u32 m0, s79, 33792
    s_nop 0
    buffer_load_dwordx4 v3, s[8:11], s63 offen lds
    s_add_u32 s63, s63, s68
    s_add_u32 m0, s79, 34816
    s_nop 0
    buffer_load_dwordx4 v4, s[8:11], s63 offen lds
    s_add_u32 s63, s63, s68
    s_add_u32 m0, s79, 35840
    s_nop 0
    buffer_load_dwordx4 v4, s[8:11], s63 offen lds
    s_add_u32 s59, s59, 1
    s_cmp_eq_u32 s59, 10
    s_cselect_b32 s59, 0, s59
    s_waitcnt vmcnt(8) lgkmcnt(0)
    s_barrier
    ds_write_b128 v26, v[192:195] offset:0
    ds_write_b128 v27, v[196:199] offset:0
    ds_write_b128 v28, v[200:203] offset:0
    ds_write_b128 v29, v[204:207] offset:0
    s_lshl_b32 s63, s59, 4
    s_mul_i32 s63, s63, s68
    s_add_u32 s63, s63, s74
    s_add_u32 m0, s79, 65536
    s_nop 0
    buffer_load_dwordx4 v3, s[8:11], s63 offen lds
    s_add_u32 s63, s63, s68
    s_add_u32 m0, s79, 66560
    s_nop 0
    buffer_load_dwordx4 v3, s[8:11], s63 offen lds
    s_add_u32 s63, s63, s68
    s_add_u32 m0, s79, 67584
    s_nop 0
    buffer_load_dwordx4 v4, s[8:11], s63 offen lds
    s_add_u32 s63, s63, s68
    s_add_u32 m0, s79, 68608
    s_nop 0
    buffer_load_dwordx4 v4, s[8:11], s63 offen lds
    s_add_u32 s59, s59, 1
    s_cmp_eq_u32 s59, 10
    s_cselect_b32 s59, 0, s59
    s_waitcnt vmcnt(8) lgkmcnt(0)
    s_barrier
    ds_write_b128 v26, v[208:211] offset:32768
    ds_write_b128 v27, v[212:215] offset:32768
    ds_write_b128 v28, v[216:219] offset:32768
    ds_write_b128 v29, v[220:223] offset:32768
    v_xor_b32 v26, 0x10000, v26
    v_xor_b32 v27, 0x10000, v27
    v_xor_b32 v28, 0x10000, v28
    v_xor_b32 v29, 0x10000, v29
    s_lshl_b32 s63, s59, 4
    s_mul_i32 s63, s63, s68
    s_add_u32 s63, s63, s74
    s_add_u32 m0, s79, 98304
    s_nop 0
    buffer_load_dwordx4 v3, s[8:11], s63 offen lds
    s_add_u32 s63, s63, s68
    s_add_u32 m0, s79, 99328
    s_nop 0
    buffer_load_dwordx4 v3, s[8:11], s63 offen lds
    s_add_u32 s63, s63, s68
    s_add_u32 m0, s79, 100352
    s_nop 0
    buffer_load_dwordx4 v4, s[8:11], s63 offen lds
    s_add_u32 s63, s63, s68
    s_add_u32 m0, s79, 101376
    s_nop 0
    buffer_load_dwordx4 v4, s[8:11], s63 offen lds
    s_add_u32 s59, s59, 1
    s_cmp_eq_u32 s59, 10
    s_cselect_b32 s59, 0, s59
    s_cmp_lg_u32 s75, 0
    s_cbranch_scc1 LH_s1pre
    buffer_load_dwordx4 v[72:75], v80, s[12:15], 0 offen sc1
    buffer_load_dwordx4 v[76:79], v81, s[12:15], 0 offen sc1
LH_s1pre:
    s_waitcnt vmcnt(8) lgkmcnt(0)
    s_barrier
    ds_write_b128 v26, v[224:227] offset:0
    ds_write_b128 v27, v[228:231] offset:0
    ds_write_b128 v28, v[232:235] offset:0
    ds_write_b128 v29, v[236:239] offset:0
    s_waitcnt vmcnt(4) lgkmcnt(0)
    s_barrier
    ds_write_b128 v26, v[240:243] offset:32768
    ds_write_b128 v27, v[244:247] offset:32768
    ds_write_b128 v28, v[248:251] offset:32768
    ds_write_b128 v29, v[252:255] offset:32768
    v_xor_b32 v26, 0x10000, v26
    v_xor_b32 v27, 0x10000, v27
    v_xor_b32 v28, 0x10000, v28
    v_xor_b32 v29, 0x10000, v29
    s_cmp_lg_u32 s75, 0
    s_cbranch_scc1 LH_s1a_ok
    s_waitcnt vmcnt(0)
    s_mov_b32 s58, 0x20000
    s_branch LH_s1a_c
LH_s1a:
    buffer_load_dwordx4 v[72:75], v80, s[12:15], 0 offen sc1
    buffer_load_dwordx4 v[76:79], v81, s[12:15], 0 offen sc1
    s_waitcnt vmcnt(0)
LH_s1a_c:
    v_cmp_eq_u32 vcc, s76, v72
    v_cmp_eq_u32 s[62:63], s77, v73
    s_nop 0
    s_and_b64 vcc, vcc, s[62:63]
    v_cmp_eq_u32 s[62:63], s76, v74
    s_nop 0
    s_and_b64 vcc, vcc, s[62:63]
    v_cmp_eq_u32 s[62:63], s77, v75
    s_nop 0
    s_and_b64 vcc, vcc, s[62:63]
    v_cmp_eq_u32 s[62:63], s76, v76
    s_nop 0
    s_and_b64 vcc, vcc, s[62:63]
    v_cmp_eq_u32 s[62:63], s77, v77
    s_nop 0
    s_and_b64 vcc, vcc, s[62:63]
    v_cmp_eq_u32 s[62:63], s76, v78
    s_nop 0
    s_and_b64 vcc, vcc, s[62:63]
    v_cmp_eq_u32 s[62:63], s77, v79
    s_nop 0
    s_and_b64 vcc, vcc, s[62:63]
    s_cmp_eq_u64 vcc, exec
    s_cbranch_scc1 LH_s1a_ok
    s_sleep 2
    s_sub_u32 s58, s58, 1
    s_cmp_lg_u32 s58, 0
    s_cbranch_scc1 LH_s1a
LH_s1a_ok:
    s_waitcnt vmcnt(0) lgkmcnt(0)
    s_barrier
    v_lshrrev_b32 v8, 5, v0
    v_mul_u32_u24 v8, 320, v8
    v_and_b32 v9, 31, v0
    v_lshl_add_u32 v3, v9, 4, v8
    s_mul_i32 s62, s57, 81920
    s_and_b32 s61, s75, 1
    s_lshr_b32 s60, s75, 1
    s_cmp_eq_u32 s60, 0
    s_mov_b32 s63, 5120
    s_cselect_b32 s63, 32768, s63
    s_cselect_b32 s64, 4096, 0
    s_cselect_b32 s90, 0, 10240
    s_mul_i32 s63, s63, s61
    s_add_u32 s62, s62, s63
    s_mul_i32 s89, s60, 2621184
    s_add_u32 s89, s89, 2621696
    s_add_u32 s89, s89, s62
    s_lshl_b32 s63, s60, 13
    s_add_u32 s64, s64, s63
    s_mul_i32 s64, s64, s61
    s_add_u32 s90, s90, s64
    s_bitcmp1_b32 s75, 1
    s_cbranch_scc1 LH_d0a_v
    s_add_u32 m0, s90, 0
    s_add_u32 s64, s89, 0
    buffer_load_dwordx4 v5, s[12:15], s64 offen offset:0 sc1 lds
    buffer_load_dwordx4 v5, s[12:15], s64 offen offset:1024 sc1 lds
    s_add_u32 m0, s90, 2048
    s_add_u32 s64, s89, 16384
    buffer_load_dwordx4 v5, s[12:15], s64 offen offset:0 sc1 lds
    buffer_load_dwordx4 v5, s[12:15], s64 offen offset:1024 sc1 lds
    s_add_u32 m0, s90, 4096
    s_add_u32 s64, s89, 32768
    buffer_load_dwordx4 v5, s[12:15], s64 offen offset:0 sc1 lds
    buffer_load_dwordx4 v5, s[12:15], s64 offen offset:1024 sc1 lds
    s_branch LH_d0a_e
LH_d0a_v:
    s_mov_b32 exec_lo, 0x000fffff
    s_mov_b32 exec_hi, 0x000fffff
    s_add_u32 m0, s90, 0
    s_add_u32 s64, s89, 0
    buffer_load_dwordx4 v3, s[12:15], s64 offen sc1 lds
    s_add_u32 m0, s90, 1024
    s_add_u32 s64, s89, 640
    buffer_load_dwordx4 v3, s[12:15], s64 offen sc1 lds
    s_add_u32 m0, s90, 2048
    s_add_u32 s64, s89, 1280
    buffer_load_dwordx4 v3, s[12:15], s64 offen sc1 lds
    s_add_u32 m0, s90, 3072
    s_add_u32 s64, s89, 1920
    buffer_load_dwordx4 v3, s[12:15], s64 offen sc1 lds
    s_add_u32 m0, s90, 4096
    s_add_u32 s64, s89, 2560
    buffer_load_dwordx4 v3, s[12:15], s64 offen sc1 lds
    s_add_u32 m0, s90, 5120
    s_add_u32 s64, s89, 3200
    buffer_load_dwordx4 v3, s[12:15], s64 offen sc1 lds
    s_add_u32 m0, s90, 6144
    s_add_u32 s64, s89, 3840
    buffer_load_dwordx4 v3, s[12:15], s64 offen sc1 lds
    s_add_u32 m0, s90, 7168
    s_add_u32 s64, s89, 4480
    buffer_load_dwordx4 v3, s[12:15], s64 offen sc1 lds
    s_mov_b64 exec, -1
LH_d0a_e:
    s_lshl_b32 s60, s75, 12
    s_add_u32 s60, s60, 10240
    v_add_u32 v12, s60, v5
    v_cmp_eq_u32 vcc, 20, v9
    v_mov_b32 v13, 0x3f803f80
    v_mov_b32 v14, 0
    v_cndmask_b32 v8, 0, v13, vcc
    v_cndmask_b32 v9, 0, v13, vcc
    v_cndmask_b32 v10, 0, v13, vcc
    v_cndmask_b32 v11, 0, v13, vcc
    s_mov_b32 exec_lo, 0xfff00000
    s_mov_b32 exec_hi, 0xfff00000
    ds_write_b128 v12, v[8:11] offset:0
    ds_write_b128 v12, v[8:11] offset:1024
    ds_write_b128 v12, v[8:11] offset:2048
    ds_write_b128 v12, v[8:11] offset:3072
    s_mov_b64 exec, -1
    s_branch LH_gemm_done
LH_short:
    s_waitcnt vmcnt(0) lgkmcnt(0)
    s_barrier
    s_barrier
    s_barrier
    s_lshr_b32 s60, s54, 2
    s_cmp_eq_u32 s54, 15
    s_cselect_b32 s60, 4, s60
    s_mul_i32 s61, s53, 5
    s_add_u32 s60, s60, s61
    s_lshl_b32 s60, s60, 2
    s_add_u32 s91, s60, s75
    v_lshrrev_b32 v130, 3, v0
    v_and_b32 v131, 7, v0
    v_lshlrev_b32 v131, 4, v131
    s_add_u32 s80, s91, 0
    s_mov_b32 s16, s40
    s_mov_b32 s17, s41
    s_mov_b32 s18, 1966080
    s_mov_b32 s19, 0x00020000
    s_mul_i32 s81, s80, 6554
    s_lshr_b32 s81, s81, 16
    s_mul_i32 s62, s81, 10
    s_sub_u32 s82, s80, s62
    s_lshl_b32 s62, s81, 5
    v_add_u32 v132, s62, v130
    v_add_u32 v133, 8, v132
    v_add_u32 v134, 16, v132
    v_add_u32 v135, 24, v132
    s_mul_i32 s83, s82, 196608
    s_lshl_b32 s62, s81, 10
    s_add_u32 s83, s83, s62
    s_add_u32 s70, s83, 14155776
    s_mov_b32 s73, 49152
    s_lshl_b32 s62, s82, 7
    s_mul_i32 s63, s75, 12288
    s_add_u32 s63, s63, 65536
    v_mul_u32_u24 v132, 1280, v132
    v_add_u32 v132, v132, v131
    s_add_u32 m0, s63, 0
    s_nop 0
    buffer_load_dwordx4 v132, s[16:19], s62 offen lds
    v_mul_u32_u24 v133, 1280, v133
    v_add_u32 v133, v133, v131
    s_add_u32 m0, s63, 1024
    s_nop 0
    buffer_load_dwordx4 v133, s[16:19], s62 offen lds
    v_mul_u32_u24 v134, 1280, v134
    v_add_u32 v134, v134, v131
    s_add_u32 m0, s63, 2048
    s_nop 0
    buffer_load_dwordx4 v134, s[16:19], s62 offen lds
    v_mul_u32_u24 v135, 1280, v135
    v_add_u32 v135, v135, v131
    s_add_u32 m0, s63, 3072
    s_nop 0
    buffer_load_dwordx4 v135, s[16:19], s62 offen lds
    s_add_u32 s80, s91, 320
    s_cmp_ge_u32 s80, 480
    s_cbranch_scc1 LH_rl_wo1
    s_mov_b32 s16, s40
    s_mov_b32 s17, s41
    s_mov_b32 s18, 1966080
    s_mov_b32 s19, 0x00020000
    s_mul_i32 s81, s80, 6554
    s_lshr_b32 s81, s81, 16
    s_mul_i32 s62, s81, 10
    s_sub_u32 s82, s80, s62
    s_lshl_b32 s62, s81, 5
    v_add_u32 v132, s62, v130
    v_add_u32 v133, 8, v132
    v_add_u32 v134, 16, v132
    v_add_u32 v135, 24, v132
    s_mul_i32 s83, s82, 196608
    s_lshl_b32 s62, s81, 10
    s_add_u32 s83, s83, s62
    s_add_u32 s71, s83, 14155776
    s_mov_b32 s89, 49152
    s_branch LH_rl_go1
LH_rl_wo1:
    s_mov_b32 s16, s32
    s_mov_b32 s17, s33
    s_mov_b32 s18, 819200
    s_mov_b32 s19, 0x00020000
    s_sub_u32 s63, s80, 480
    s_mul_i32 s81, s63, 6554
    s_lshr_b32 s81, s81, 16
    s_mul_i32 s62, s81, 10
    s_sub_u32 s82, s63, s62
    s_lshl_b32 s62, s81, 2
    v_lshrrev_b32 v136, 2, v130
    v_add_u32 v136, s62, v136
    v_and_b32 v137, 3, v130
    v_add_u32 v138, 0, v136
    v_mul_u32_u24 v139, 205, v138
    v_lshrrev_b32 v139, 10, v139
    v_mul_u32_u24 v140, 5, v139
    v_sub_u32 v140, v138, v140
    v_lshlrev_b32 v140, 2, v140
    s_mov_b32 s63, 0x65410
    v_lshrrev_b32 v140, v140, s63
    v_and_b32 v140, 15, v140
    v_mul_u32_u24 v139, 40, v139
    v_lshl_add_u32 v139, v140, 2, v139
    v_add_u32 v132, v139, v137
    v_add_u32 v138, 2, v136
    v_mul_u32_u24 v139, 205, v138
    v_lshrrev_b32 v139, 10, v139
    v_mul_u32_u24 v140, 5, v139
    v_sub_u32 v140, v138, v140
    v_lshlrev_b32 v140, 2, v140
    s_mov_b32 s63, 0x65410
    v_lshrrev_b32 v140, v140, s63
    v_and_b32 v140, 15, v140
    v_mul_u32_u24 v139, 40, v139
    v_lshl_add_u32 v139, v140, 2, v139
    v_add_u32 v133, v139, v137
    v_add_u32 v138, 0, v136
    v_mul_u32_u24 v139, 205, v138
    v_lshrrev_b32 v139, 10, v139
    v_mul_u32_u24 v140, 5, v139
    v_sub_u32 v140, v138, v140
    v_lshlrev_b32 v140, 2, v140
    s_mov_b32 s63, 0x87932
    v_lshrrev_b32 v140, v140, s63
    v_and_b32 v140, 15, v140
    v_mul_u32_u24 v139, 40, v139
    v_lshl_add_u32 v139, v140, 2, v139
    v_add_u32 v134, v139, v137
    v_add_u32 v138, 2, v136
    v_mul_u32_u24 v139, 205, v138
    v_lshrrev_b32 v139, 10, v139
    v_mul_u32_u24 v140, 5, v139
    v_sub_u32 v140, v138, v140
    v_lshlrev_b32 v140, 2, v140
    s_mov_b32 s63, 0x87932
    v_lshrrev_b32 v140, v140, s63
    v_and_b32 v140, 15, v140
    v_mul_u32_u24 v139, 40, v139
    v_lshl_add_u32 v139, v140, 2, v139
    v_add_u32 v135, v139, v137
    s_mul_i32 s83, s82, 81920
    s_lshl_b32 s62, s81, 10
    s_add_u32 s83, s83, s62
    s_add_u32 s83, s83, 16121856
    s_mov_b32 s89, 20480
    s_cmp_lt_u32 s80, 680
    s_cselect_b32 s71, s83, 0x7f000000
LH_rl_go1:
    s_lshl_b32 s62, s82, 7
    s_mul_i32 s63, s75, 12288
    s_add_u32 s63, s63, 69632
    v_mul_u32_u24 v132, 1280, v132
    v_add_u32 v132, v132, v131
    s_add_u32 m0, s63, 0
    s_nop 0
    buffer_load_dwordx4 v132, s[16:19], s62 offen lds
    v_mul_u32_u24 v133, 1280, v133
    v_add_u32 v133, v133, v131
    s_add_u32 m0, s63, 1024
    s_nop 0
    buffer_load_dwordx4 v133, s[16:19], s62 offen lds
    v_mul_u32_u24 v134, 1280, v134
    v_add_u32 v134, v134, v131
    s_add_u32 m0, s63, 2048
    s_nop 0
    buffer_load_dwordx4 v134, s[16:19], s62 offen lds
    v_mul_u32_u24 v135, 1280, v135
    v_add_u32 v135, v135, v131
    s_add_u32 m0, s63, 3072
    s_nop 0
    buffer_load_dwordx4 v135, s[16:19], s62 offen lds
    s_add_u32 s80, s91, 640
    s_mov_b32 s16, s32
    s_mov_b32 s17, s33
    s_mov_b32 s18, 819200
    s_mov_b32 s19, 0x00020000
    s_sub_u32 s63, s80, 480
    s_mul_i32 s81, s63, 6554
    s_lshr_b32 s81, s81, 16
    s_mul_i32 s62, s81, 10
    s_sub_u32 s82, s63, s62
    s_lshl_b32 s62, s81, 2
    v_lshrrev_b32 v136, 2, v130
    v_add_u32 v136, s62, v136
    v_and_b32 v137, 3, v130
    v_add_u32 v138, 0, v136
    v_mul_u32_u24 v139, 205, v138
    v_lshrrev_b32 v139, 10, v139
    v_mul_u32_u24 v140, 5, v139
    v_sub_u32 v140, v138, v140
    v_lshlrev_b32 v140, 2, v140
    s_mov_b32 s63, 0x65410
    v_lshrrev_b32 v140, v140, s63
    v_and_b32 v140, 15, v140
    v_mul_u32_u24 v139, 40, v139
    v_lshl_add_u32 v139, v140, 2, v139
    v_add_u32 v132, v139, v137
    v_add_u32 v138, 2, v136
    v_mul_u32_u24 v139, 205, v138
    v_lshrrev_b32 v139, 10, v139
    v_mul_u32_u24 v140, 5, v139
    v_sub_u32 v140, v138, v140
    v_lshlrev_b32 v140, 2, v140
    s_mov_b32 s63, 0x65410
    v_lshrrev_b32 v140, v140, s63
    v_and_b32 v140, 15, v140
    v_mul_u32_u24 v139, 40, v139
    v_lshl_add_u32 v139, v140, 2, v139
    v_add_u32 v133, v139, v137
    v_add_u32 v138, 0, v136
    v_mul_u32_u24 v139, 205, v138
    v_lshrrev_b32 v139, 10, v139
    v_mul_u32_u24 v140, 5, v139
    v_sub_u32 v140, v138, v140
    v_lshlrev_b32 v140, 2, v140
    s_mov_b32 s63, 0x87932
    v_lshrrev_b32 v140, v140, s63
    v_and_b32 v140, 15, v140
    v_mul_u32_u24 v139, 40, v139
    v_lshl_add_u32 v139, v140, 2, v139
    v_add_u32 v134, v139, v137
    v_add_u32 v138, 2, v136
    v_mul_u32_u24 v139, 205, v138
    v_lshrrev_b32 v139, 10, v139
    v_mul_u32_u24 v140, 5, v139
    v_sub_u32 v140, v138, v140
    v_lshlrev_b32 v140, 2, v140
    s_mov_b32 s63, 0x87932
    v_lshrrev_b32 v140, v140, s63
    v_and_b32 v140, 15, v140
    v_mul_u32_u24 v139, 40, v139
    v_lshl_add_u32 v139, v140, 2, v139
    v_add_u32 v135, v139, v137
    s_mul_i32 s83, s82, 81920
    s_lshl_b32 s62, s81, 10
    s_add_u32 s83, s83, s62
    s_add_u32 s83, s83, 16121856
    s_mov_b32 s90, 20480
    s_cmp_lt_u32 s80, 680
    s_cselect_b32 s72, s83, 0x7f000000
    s_lshl_b32 s62, s82, 7
    s_mul_i32 s63, s75, 12288
    s_add_u32 s63, s63, 73728
    v_mul_u32_u24 v132, 1280, v132
    v_add_u32 v132, v132, v131
    s_add_u32 m0, s63, 0
    s_nop 0
    buffer_load_dwordx4 v132, s[16:19], s62 offen lds
    v_mul_u32_u24 v133, 1280, v133
    v_add_u32 v133, v133, v131
    s_add_u32 m0, s63, 1024
    s_nop 0
    buffer_load_dwordx4 v133, s[16:19], s62 offen lds
    v_mul_u32_u24 v134, 1280, v134
    v_add_u32 v134, v134, v131
    s_add_u32 m0, s63, 2048
    s_nop 0
    buffer_load_dwordx4 v134, s[16:19], s62 offen lds
    v_mul_u32_u24 v135, 1280, v135
    v_add_u32 v135, v135, v131
    s_add_u32 m0, s63, 3072
    s_nop 0
    buffer_load_dwordx4 v135, s[16:19], s62 offen lds
    s_mov_b32 s16, s44
    s_mov_b32 s17, s45
    s_mov_b32 s18, 1280
    s_mov_b32 s19, 0x00020000
    v_and_b32 v100, 31, v0
    v_mul_u32_u24 v100, 40, v100
    v_lshrrev_b32 v101, 5, v0
    v_mul_u32_u24 v101, 1280, v101
    v_add_u32 v101, v101, v100
    buffer_load_dwordx4 v[116:119], v100, s[16:19], 0 offen
    buffer_load_dwordx4 v[120:123], v100, s[16:19], 0 offen offset:16
    buffer_load_dwordx2 v[124:125], v100, s[16:19], 0 offen offset:32
    s_add_u32 s63, s91, 0
    s_mul_i32 s63, s63, 2560
    buffer_load_dwordx4 v[200:203], v101, s[4:7], s63 offen
    buffer_load_dwordx4 v[204:207], v101, s[4:7], s63 offen offset:16
    buffer_load_dwordx2 v[208:209], v101, s[4:7], s63 offen offset:32
    s_add_u32 s63, s91, 320
    s_mul_i32 s63, s63, 2560
    buffer_load_dwordx4 v[212:215], v101, s[4:7], s63 offen
    buffer_load_dwordx4 v[216:219], v101, s[4:7], s63 offen offset:16
    buffer_load_dwordx2 v[220:221], v101, s[4:7], s63 offen offset:32
    s_add_u32 s63, s91, 640
    s_mul_i32 s63, s63, 2560
    buffer_load_dwordx4 v[224:227], v101, s[4:7], s63 offen
    buffer_load_dwordx4 v[228:231], v101, s[4:7], s63 offen offset:16
    buffer_load_dwordx2 v[232:233], v101, s[4:7], s63 offen offset:32
    s_add_u32 s63, s91, 960
    s_mul_i32 s63, s63, 2560
    buffer_load_dwordx4 v[236:239], v101, s[4:7], s63 offen
    buffer_load_dwordx4 v[240:243], v101, s[4:7], s63 offen offset:16
    buffer_load_dwordx2 v[244:245], v101, s[4:7], s63 offen offset:32
    v_lshrrev_b32 v130, 2, v0
    v_lshlrev_b32 v130, 7, v130
    v_and_b32 v131, 3, v0
    v_lshl_add_u32 v130, v131, 4, v130
    s_mul_i32 s63, s75, 12288
    s_add_u32 s63, s63, 65536
    v_add_u32 v130, s63, v130
    s_waitcnt vmcnt(23)
    ds_read_b64_tr_b16 v[144:145], v130 offset:0
    ds_read_b64_tr_b16 v[146:147], v130 offset:2048
    ds_read_b64_tr_b16 v[148:149], v130 offset:8
    ds_read_b64_tr_b16 v[150:151], v130 offset:2056
    ds_read_b64_tr_b16 v[152:153], v130 offset:64
    ds_read_b64_tr_b16 v[154:155], v130 offset:2112
    ds_read_b64_tr_b16 v[156:157], v130 offset:72
    ds_read_b64_tr_b16 v[158:159], v130 offset:2120
    s_waitcnt lgkmcnt(0)
    buffer_store_dwordx4 v[144:147], v5, s[12:15], s70 offen sc1
    s_add_u32 s70, s70, s73
    buffer_store_dwordx4 v[148:151], v5, s[12:15], s70 offen sc1
    s_add_u32 s70, s70, s73
    buffer_store_dwordx4 v[152:155], v5, s[12:15], s70 offen sc1
    s_add_u32 s70, s70, s73
    buffer_store_dwordx4 v[156:159], v5, s[12:15], s70 offen sc1
    s_cmp_lg_u32 s75, 0
    s_cbranch_scc1 LH_s1q
    buffer_load_dwordx4 v[72:75], v80, s[12:15], 0 offen sc1
    buffer_load_dwordx4 v[76:79], v81, s[12:15], 0 offen sc1
LH_s1q:
    s_waitcnt vmcnt(23)
    ds_read_b64_tr_b16 v[160:161], v130 offset:4096
    ds_read_b64_tr_b16 v[162:163], v130 offset:6144
    ds_read_b64_tr_b16 v[164:165], v130 offset:4104
    ds_read_b64_tr_b16 v[166:167], v130 offset:6152
    ds_read_b64_tr_b16 v[168:169], v130 offset:4160
    ds_read_b64_tr_b16 v[170:171], v130 offset:6208
    ds_read_b64_tr_b16 v[172:173], v130 offset:4168
    ds_read_b64_tr_b16 v[174:175], v130 offset:6216
    s_waitcnt lgkmcnt(0)
    buffer_store_dwordx4 v[160:163], v5, s[12:15], s71 offen sc1
    s_add_u32 s71, s71, s89
    buffer_store_dwordx4 v[164:167], v5, s[12:15], s71 offen sc1
    s_add_u32 s71, s71, s89
    buffer_store_dwordx4 v[168:171], v5, s[12:15], s71 offen sc1
    s_add_u32 s71, s71, s89
    buffer_store_dwordx4 v[172:175], v5, s[12:15], s71 offen sc1
    s_waitcnt vmcnt(23)
    ds_read_b64_tr_b16 v[176:177], v130 offset:8192
    ds_read_b64_tr_b16 v[178:179], v130 offset:10240
    ds_read_b64_tr_b16 v[180:181], v130 offset:8200
    ds_read_b64_tr_b16 v[182:183], v130 offset:10248
    ds_read_b64_tr_b16 v[184:185], v130 offset:8256
    ds_read_b64_tr_b16 v[186:187], v130 offset:10304
    ds_read_b64_tr_b16 v[188:189], v130 offset:8264
    ds_read_b64_tr_b16 v[190:191], v130 offset:10312
    s_waitcnt lgkmcnt(0)
    buffer_store_dwordx4 v[176:179], v5, s[12:15], s72 offen sc1
    s_add_u32 s72, s72, s90
    buffer_store_dwordx4 v[180:183], v5, s[12:15], s72 offen sc1
    s_add_u32 s72, s72, s90
    buffer_store_dwordx4 v[184:187], v5, s[12:15], s72 offen sc1
    s_add_u32 s72, s72, s90
    buffer_store_dwordx4 v[188:191], v5, s[12:15], s72 offen sc1
    v_and_b32 v128, 31, v0
    v_cmp_eq_u32 vcc, 31, v128
    v_lshrrev_b32 v128, 5, v0
    v_lshlrev_b32 v128, 2, v128
    v_mov_b32 v129, 0x7fffffff
    v_cndmask_b32 v128, v129, v128, vcc
    s_waitcnt vmcnt(12)
    v_mov_b32 v104, 0
    v_mov_b32 v106, 0
    v_mov_b32 v108, 0
    v_mov_b32 v110, 0
    v_dot2_f32_bf16 v104, v200, v116, v104
    v_dot2_f32_bf16 v106, v212, v116, v106
    v_dot2_f32_bf16 v108, v224, v116, v108
    v_dot2_f32_bf16 v110, v236, v116, v110
    v_dot2_f32_bf16 v104, v201, v117, v104
    v_dot2_f32_bf16 v106, v213, v117, v106
    v_dot2_f32_bf16 v108, v225, v117, v108
    v_dot2_f32_bf16 v110, v237, v117, v110
    v_dot2_f32_bf16 v104, v202, v118, v104
    v_dot2_f32_bf16 v106, v214, v118, v106
    v_dot2_f32_bf16 v108, v226, v118, v108
    v_dot2_f32_bf16 v110, v238, v118, v110
    v_dot2_f32_bf16 v104, v203, v119, v104
    v_dot2_f32_bf16 v106, v215, v119, v106
    v_dot2_f32_bf16 v108, v227, v119, v108
    v_dot2_f32_bf16 v110, v239, v119, v110
    v_dot2_f32_bf16 v104, v204, v120, v104
    v_dot2_f32_bf16 v106, v216, v120, v106
    v_dot2_f32_bf16 v108, v228, v120, v108
    v_dot2_f32_bf16 v110, v240, v120, v110
    v_dot2_f32_bf16 v104, v205, v121, v104
    v_dot2_f32_bf16 v106, v217, v121, v106
    v_dot2_f32_bf16 v108, v229, v121, v108
    v_dot2_f32_bf16 v110, v241, v121, v110
    v_dot2_f32_bf16 v104, v206, v122, v104
    v_dot2_f32_bf16 v106, v218, v122, v106
    v_dot2_f32_bf16 v108, v230, v122, v108
    v_dot2_f32_bf16 v110, v242, v122, v110
    v_dot2_f32_bf16 v104, v207, v123, v104
    v_dot2_f32_bf16 v106, v219, v123, v106
    v_dot2_f32_bf16 v108, v231, v123, v108
    v_dot2_f32_bf16 v110, v243, v123, v110
    v_dot2_f32_bf16 v104, v208, v124, v104
    v_dot2_f32_bf16 v106, v220, v124, v106
    v_dot2_f32_bf16 v108, v232, v124, v108
    v_dot2_f32_bf16 v110, v244, v124, v110
    v_dot2_f32_bf16 v104, v209, v125, v104
    v_dot2_f32_bf16 v106, v221, v125, v106
    v_dot2_f32_bf16 v108, v233, v125, v108
    v_dot2_f32_bf16 v110, v245, v125, v110
    v_add_f32 v104, v104, v104 row_shr:1 bound_ctrl:0
    v_add_f32 v106, v106, v106 row_shr:1 bound_ctrl:0
    v_add_f32 v108, v108, v108 row_shr:1 bound_ctrl:0
    v_add_f32 v110, v110, v110 row_shr:1 bound_ctrl:0
    v_add_f32 v104, v104, v104 row_shr:2 bound_ctrl:0
    v_add_f32 v106, v106, v106 row_shr:2 bound_ctrl:0
    v_add_f32 v108, v108, v108 row_shr:2 bound_ctrl:0
    v_add_f32 v110, v110, v110 row_shr:2 bound_ctrl:0
    v_add_f32 v104, v104, v104 row_shr:4 bound_ctrl:0
    v_add_f32 v106, v106, v106 row_shr:4 bound_ctrl:0
    v_add_f32 v108, v108, v108 row_shr:4 bound_ctrl:0
    v_add_f32 v110, v110, v110 row_shr:4 bound_ctrl:0
    v_add_f32 v104, v104, v104 row_shr:8 bound_ctrl:0
    v_add_f32 v106, v106, v106 row_shr:8 bound_ctrl:0
    v_add_f32 v108, v108, v108 row_shr:8 bound_ctrl:0
    v_add_f32 v110, v110, v110 row_shr:8 bound_ctrl:0
    v_add_f32 v104, v104, v104 row_bcast:15 row_mask:0xa
    v_add_f32 v106, v106, v106 row_bcast:15 row_mask:0xa
    v_add_f32 v108, v108, v108 row_bcast:15 row_mask:0xa
    v_add_f32 v110, v110, v110 row_bcast:15 row_mask:0xa
    v_mul_f32 v104, 0x3fb8aa3b, v104
    v_mul_f32 v106, 0x3fb8aa3b, v106
    v_mul_f32 v108, 0x3fb8aa3b, v108
    v_mul_f32 v110, 0x3fb8aa3b, v110
    v_min_f32 v104, 0x42ac0000, v104
    v_min_f32 v106, 0x42ac0000, v106
    v_min_f32 v108, 0x42ac0000, v108
    v_min_f32 v110, 0x42ac0000, v110
    v_max_f32 v104, 0xc2ac0000, v104
    v_max_f32 v106, 0xc2ac0000, v106
    v_max_f32 v108, 0xc2ac0000, v108
    v_max_f32 v110, 0xc2ac0000, v110
    v_exp_f32 v104, v104
    v_exp_f32 v106, v106
    v_exp_f32 v108, v108
    v_exp_f32 v110, v110
    v_add_f32 v105, 1.0, v104
    v_add_f32 v107, 1.0, v106
    v_add_f32 v109, 1.0, v108
    v_add_f32 v111, 1.0, v110
    v_rcp_f32 v105, v105
    v_rcp_f32 v107, v107
    v_rcp_f32 v109, v109
    v_rcp_f32 v111, v111
    s_add_u32 s63, s91, 0
    s_cmp_lt_u32 s63, 1024
    s_cselect_b32 s63, s63, 0x0f000000
    s_lshl_b32 s63, s63, 3
    s_add_u32 s63, s63, 19562496
    buffer_store_dword v104, v128, s[12:15], s63 offen sc1
    s_add_u32 s63, s63, 8192
    buffer_store_dword v105, v128, s[12:15], s63 offen sc1
    s_add_u32 s63, s91, 320
    s_cmp_lt_u32 s63, 1024
    s_cselect_b32 s63, s63, 0x0f000000
    s_lshl_b32 s63, s63, 3
    s_add_u32 s63, s63, 19562496
    buffer_store_dword v106, v128, s[12:15], s63 offen sc1
    s_add_u32 s63, s63, 8192
    buffer_store_dword v107, v128, s[12:15], s63 offen sc1
    s_add_u32 s63, s91, 640
    s_cmp_lt_u32 s63, 1024
    s_cselect_b32 s63, s63, 0x0f000000
    s_lshl_b32 s63, s63, 3
    s_add_u32 s63, s63, 19562496
    buffer_store_dword v108, v128, s[12:15], s63 offen sc1
    s_add_u32 s63, s63, 8192
    buffer_store_dword v109, v128, s[12:15], s63 offen sc1
    s_add_u32 s63, s91, 960
    s_cmp_lt_u32 s63, 1024
    s_cselect_b32 s63, s63, 0x0f000000
    s_lshl_b32 s63, s63, 3
    s_add_u32 s63, s63, 19562496
    buffer_store_dword v110, v128, s[12:15], s63 offen sc1
    s_add_u32 s63, s63, 8192
    buffer_store_dword v111, v128, s[12:15], s63 offen sc1
    s_cmp_lg_u32 s75, 0
    s_cbranch_scc1 LH_s1b_ok
    s_waitcnt vmcnt(16)
    s_mov_b32 s58, 0x20000
    s_branch LH_s1b_c
LH_s1b:
    buffer_load_dwordx4 v[72:75], v80, s[12:15], 0 offen sc1
    buffer_load_dwordx4 v[76:79], v81, s[12:15], 0 offen sc1
    s_waitcnt vmcnt(0)
LH_s1b_c:
    v_cmp_eq_u32 vcc, s76, v72
    v_cmp_eq_u32 s[62:63], s77, v73
    s_nop 0
    s_and_b64 vcc, vcc, s[62:63]
    v_cmp_eq_u32 s[62:63], s76, v74
    s_nop 0
    s_and_b64 vcc, vcc, s[62:63]
    v_cmp_eq_u32 s[62:63], s77, v75
    s_nop 0
    s_and_b64 vcc, vcc, s[62:63]
    v_cmp_eq_u32 s[62:63], s76, v76
    s_nop 0
    s_and_b64 vcc, vcc, s[62:63]
    v_cmp_eq_u32 s[62:63], s77, v77
    s_nop 0
    s_and_b64 vcc, vcc, s[62:63]
    v_cmp_eq_u32 s[62:63], s76, v78
    s_nop 0
    s_and_b64 vcc, vcc, s[62:63]
    v_cmp_eq_u32 s[62:63], s77, v79
    s_nop 0
    s_and_b64 vcc, vcc, s[62:63]
    s_cmp_eq_u64 vcc, exec
    s_cbranch_scc1 LH_s1b_ok
    s_sleep 8
    s_sub_u32 s58, s58, 1
    s_cmp_lg_u32 s58, 0
    s_cbranch_scc1 LH_s1b
LH_s1b_ok:
    s_barrier
    v_lshrrev_b32 v8, 5, v0
    v_mul_u32_u24 v8, 320, v8
    v_and_b32 v9, 31, v0
    v_lshl_add_u32 v3, v9, 4, v8
    s_mul_i32 s62, s57, 81920
    s_and_b32 s61, s75, 1
    s_lshr_b32 s60, s75, 1
    s_cmp_eq_u32 s60, 0
    s_mov_b32 s63, 5120
    s_cselect_b32 s63, 32768, s63
    s_cselect_b32 s64, 4096, 0
    s_cselect_b32 s90, 0, 10240
    s_mul_i32 s63, s63, s61
    s_add_u32 s62, s62, s63
    s_mul_i32 s89, s60, 2621184
    s_add_u32 s89, s89, 2621696
    s_add_u32 s89, s89, s62
    s_lshl_b32 s63, s60, 13
    s_add_u32 s64, s64, s63
    s_mul_i32 s64, s64, s61
    s_add_u32 s90, s90, s64
    s_bitcmp1_b32 s75, 1
    s_cbranch_scc1 LH_d0b_v
    s_add_u32 m0, s90, 0
    s_add_u32 s64, s89, 0
    buffer_load_dwordx4 v5, s[12:15], s64 offen offset:0 sc1 lds
    buffer_load_dwordx4 v5, s[12:15], s64 offen offset:1024 sc1 lds
    s_add_u32 m0, s90, 2048
    s_add_u32 s64, s89, 16384
    buffer_load_dwordx4 v5, s[12:15], s64 offen offset:0 sc1 lds
    buffer_load_dwordx4 v5, s[12:15], s64 offen offset:1024 sc1 lds
    s_add_u32 m0, s90, 4096
    s_add_u32 s64, s89, 32768
    buffer_load_dwordx4 v5, s[12:15], s64 offen offset:0 sc1 lds
    buffer_load_dwordx4 v5, s[12:15], s64 offen offset:1024 sc1 lds
    s_branch LH_d0b_e
LH_d0b_v:
    s_mov_b32 exec_lo, 0x000fffff
    s_mov_b32 exec_hi, 0x000fffff
    s_add_u32 m0, s90, 0
    s_add_u32 s64, s89, 0
    buffer_load_dwordx4 v3, s[12:15], s64 offen sc1 lds
    s_add_u32 m0, s90, 1024
    s_add_u32 s64, s89, 640
    buffer_load_dwordx4 v3, s[12:15], s64 offen sc1 lds
    s_add_u32 m0, s90, 2048
    s_add_u32 s64, s89, 1280
    buffer_load_dwordx4 v3, s[12:15], s64 offen sc1 lds
    s_add_u32 m0, s90, 3072
    s_add_u32 s64, s89, 1920
    buffer_load_dwordx4 v3, s[12:15], s64 offen sc1 lds
    s_add_u32 m0, s90, 4096
    s_add_u32 s64, s89, 2560
    buffer_load_dwordx4 v3, s[12:15], s64 offen sc1 lds
    s_add_u32 m0, s90, 5120
    s_add_u32 s64, s89, 3200
    buffer_load_dwordx4 v3, s[12:15], s64 offen sc1 lds
    s_add_u32 m0, s90, 6144
    s_add_u32 s64, s89, 3840
    buffer_load_dwordx4 v3, s[12:15], s64 offen sc1 lds
    s_add_u32 m0, s90, 7168
    s_add_u32 s64, s89, 4480
    buffer_load_dwordx4 v3, s[12:15], s64 offen sc1 lds
    s_mov_b64 exec, -1
LH_d0b_e:
    s_lshl_b32 s60, s75, 12
    s_add_u32 s60, s60, 10240
    v_add_u32 v12, s60, v5
    v_cmp_eq_u32 vcc, 20, v9
    v_mov_b32 v13, 0x3f803f80
    v_mov_b32 v14, 0
    v_cndmask_b32 v8, 0, v13, vcc
    v_cndmask_b32 v9, 0, v13, vcc
    v_cndmask_b32 v10, 0, v13, vcc
    v_cndmask_b32 v11, 0, v13, vcc
    s_mov_b32 exec_lo, 0xfff00000
    s_mov_b32 exec_hi, 0xfff00000
    ds_write_b128 v12, v[8:11] offset:0
    ds_write_b128 v12, v[8:11] offset:1024
    ds_write_b128 v12, v[8:11] offset:2048
    ds_write_b128 v12, v[8:11] offset:3072
    s_mov_b64 exec, -1
LH_gemm_done:
    s_setprio 3
    s_mov_b32 s16, s42
    s_mov_b32 s17, s43
    s_mov_b32 s18, 1280
    s_mov_b32 s19, 0x00020000
    v_lshrrev_b32 v102, 4, v0
    v_lshlrev_b32 v102, 4, v102
    s_add_u32 s60, s88, 0
    s_lshr_b32 s61, s60, 1
    s_lshl_b32 s61, s61, 6
    s_and_b32 s60, s60, 1
    s_lshl_b32 s60, s60, 3
    s_add_u32 s60, s60, s61
    buffer_load_dwordx2 v[224:225], v102, s[16:19], s60 offen
    s_add_u32 s60, s88, 1
    s_lshr_b32 s61, s60, 1
    s_lshl_b32 s61, s61, 6
    s_and_b32 s60, s60, 1
    s_lshl_b32 s60, s60, 3
    s_add_u32 s60, s60, s61
    buffer_load_dwordx2 v[226:227], v102, s[16:19], s60 offen
    s_add_u32 s60, s88, 2
    s_lshr_b32 s61, s60, 1
    s_lshl_b32 s61, s61, 6
    s_and_b32 s60, s60, 1
    s_lshl_b32 s60, s60, 3
    s_add_u32 s60, s60, s61
    buffer_load_dwordx2 v[228:229], v102, s[16:19], s60 offen
    s_add_u32 s60, s88, 3
    s_lshr_b32 s61, s60, 1
    s_lshl_b32 s61, s61, 6
    s_and_b32 s60, s60, 1
    s_lshl_b32 s60, s60, 3
    s_add_u32 s60, s60, s61
    buffer_load_dwordx2 v[230:231], v102, s[16:19], s60 offen
    s_add_u32 s60, s88, 4
    s_lshr_b32 s61, s60, 1
    s_lshl_b32 s61, s61, 6
    s_and_b32 s60, s60, 1
    s_lshl_b32 s60, s60, 3
    s_add_u32 s60, s60, s61
    buffer_load_dwordx2 v[232:233], v102, s[16:19], s60 offen
    s_lshr_b32 s60, s75, 1
    s_and_b32 s61, s75, 1
    v_and_b32 v16, 15, v0
    v_lshrrev_b32 v17, 4, v0
    s_lshl_b32 s62, s53, 1
    s_add_u32 s62, s62, s60
    s_mul_i32 s62, s62, 196608
    s_lshr_b32 s63, s95, 5
    s_lshl_b32 s64, s61, 1
    s_add_u32 s63, s63, s64
    s_lshl_b32 s63, s63, 10
    s_add_u32 s62, s62, s63
    s_add_u32 s86, s62, 7864320
    v_add_u32 v64, 0, v5
    v_add_u32 v65, 1024, v5
    v_add_u32 v66, 49152, v5
    v_add_u32 v67, 50176, v5
    v_add_u32 v68, 98304, v5
    v_add_u32 v69, 99328, v5
    v_add_u32 v70, 147456, v5
    v_add_u32 v71, 148480, v5
    s_lshl_b32 s60, s75, 13
    s_add_u32 s60, s60, 131072
    v_add_u32 v16, s60, v5
    s_cmp_eq_u32 s54, 15
    s_cselect_b32 s60, 1, s94
    s_cmp_eq_u32 s60, 0
    s_cselect_b32 s86, 0x7f000000, s86
    s_waitcnt vmcnt(5) lgkmcnt(0)
    s_barrier
    s_mov_b32 exec_lo, 0xfff00000
    s_mov_b32 exec_hi, 0xfff00000
    ds_write_b128 v12, v[8:11] offset:26624
    ds_write_b128 v12, v[8:11] offset:27648
    ds_write_b128 v12, v[8:11] offset:28672
    ds_write_b128 v12, v[8:11] offset:29696
    s_mov_b64 exec, -1
    v_mov_b32 v13, 53248
    v_mov_b32 v6, 0
    v_mov_b32 v7, 0
    ds_write_b64 v13, v[6:7]
    s_bitcmp1_b32 s75, 1
    s_cbranch_scc1 LH_d1_v
    s_add_u32 m0, s90, 26624
    s_add_u32 s64, s89, 2048
    buffer_load_dwordx4 v5, s[12:15], s64 offen offset:0 sc1 lds
    buffer_load_dwordx4 v5, s[12:15], s64 offen offset:1024 sc1 lds
    s_add_u32 m0, s90, 28672
    s_add_u32 s64, s89, 18432
    buffer_load_dwordx4 v5, s[12:15], s64 offen offset:0 sc1 lds
    buffer_load_dwordx4 v5, s[12:15], s64 offen offset:1024 sc1 lds
    s_add_u32 m0, s90, 30720
    s_add_u32 s64, s89, 34816
    buffer_load_dwordx4 v5, s[12:15], s64 offen offset:0 sc1 lds
    buffer_load_dwordx4 v5, s[12:15], s64 offen offset:1024 sc1 lds
    s_branch LH_d1_e
LH_d1_v:
    s_mov_b32 exec_lo, 0x000fffff
    s_mov_b32 exec_hi, 0x000fffff
    s_add_u32 m0, s90, 26624
    s_add_u32 s64, s89, 10240
    buffer_load_dwordx4 v3, s[12:15], s64 offen sc1 lds
    s_add_u32 m0, s90, 27648
    s_add_u32 s64, s89, 10880
    buffer_load_dwordx4 v3, s[12:15], s64 offen sc1 lds
    s_add_u32 m0, s90, 28672
    s_add_u32 s64, s89, 11520
    buffer_load_dwordx4 v3, s[12:15], s64 offen sc1 lds
    s_add_u32 m0, s90, 29696
    s_add_u32 s64, s89, 12160
    buffer_load_dwordx4 v3, s[12:15], s64 offen sc1 lds
    s_add_u32 m0, s90, 30720
    s_add_u32 s64, s89, 12800
    buffer_load_dwordx4 v3, s[12:15], s64 offen sc1 lds
    s_add_u32 m0, s90, 31744
    s_add_u32 s64, s89, 13440
    buffer_load_dwordx4 v3, s[12:15], s64 offen sc1 lds
    s_add_u32 m0, s90, 32768
    s_add_u32 s64, s89, 14080
    buffer_load_dwordx4 v3, s[12:15], s64 offen sc1 lds
    s_add_u32 m0, s90, 33792
    s_add_u32 s64, s89, 14720
    buffer_load_dwordx4 v3, s[12:15], s64 offen sc1 lds
    s_mov_b64 exec, -1
LH_d1_e:
    ds_read_b128 v[32:35], v16 offset:0
    ds_read_b128 v[36:39], v16 offset:1024
    ds_read_b128 v[40:43], v16 offset:2048
    ds_read_b128 v[44:47], v16 offset:3072
    ds_read_b128 v[48:51], v16 offset:4096
    ds_read_b128 v[52:55], v16 offset:5120
    ds_read_b128 v[56:59], v16 offset:6144
    ds_read_b128 v[60:63], v16 offset:7168
    s_waitcnt lgkmcnt(7)
    buffer_store_dwordx4 v[32:35], v64, s[12:15], s86 offen sc1
    s_waitcnt lgkmcnt(6)
    buffer_store_dwordx4 v[36:39], v65, s[12:15], s86 offen sc1
    s_waitcnt lgkmcnt(5)
    buffer_store_dwordx4 v[40:43], v66, s[12:15], s86 offen sc1
    s_waitcnt lgkmcnt(4)
    buffer_store_dwordx4 v[44:47], v67, s[12:15], s86 offen sc1
    s_waitcnt lgkmcnt(3)
    buffer_store_dwordx4 v[48:51], v68, s[12:15], s86 offen sc1
    s_waitcnt lgkmcnt(2)
    buffer_store_dwordx4 v[52:55], v69, s[12:15], s86 offen sc1
    s_waitcnt lgkmcnt(1)
    buffer_store_dwordx4 v[56:59], v70, s[12:15], s86 offen sc1
    s_waitcnt lgkmcnt(0)
    buffer_store_dwordx4 v[60:63], v71, s[12:15], s86 offen sc1
    s_waitcnt vmcnt(8)
    v_lshlrev_b32 v204, 16, v224
    v_and_b32 v205, 0xffff0000, v224
    v_lshlrev_b32 v206, 16, v225
    v_and_b32 v207, 0xffff0000, v225
    v_lshlrev_b32 v208, 16, v226
    v_and_b32 v209, 0xffff0000, v226
    v_lshlrev_b32 v210, 16, v227
    v_and_b32 v211, 0xffff0000, v227
    v_lshlrev_b32 v212, 16, v228
    v_and_b32 v213, 0xffff0000, v228
    v_lshlrev_b32 v214, 16, v229
    v_and_b32 v215, 0xffff0000, v229
    v_lshlrev_b32 v216, 16, v230
    v_and_b32 v217, 0xffff0000, v230
    v_lshlrev_b32 v218, 16, v231
    v_and_b32 v219, 0xffff0000, v231
    v_lshlrev_b32 v220, 16, v232
    v_and_b32 v221, 0xffff0000, v232
    v_lshlrev_b32 v222, 16, v233
    v_and_b32 v223, 0xffff0000, v233
    s_mul_i32 s61, s75, 12288
    s_lshr_b32 s60, s87, 4
    s_add_u32 s62, s75, 0
    s_and_b32 s62, s62, 3
    s_add_u32 s62, s62, s60
    s_mul_i32 s62, s62, 49152
    s_add_u32 s62, s62, s61
    s_add_u32 s70, s62, 7864320
    s_add_u32 s62, s75, 1
    s_and_b32 s62, s62, 3
    s_add_u32 s62, s62, s60
    s_mul_i32 s62, s62, 49152
    s_add_u32 s62, s62, s61
    s_add_u32 s71, s62, 7864320
    s_add_u32 s62, s75, 2
    s_and_b32 s62, s62, 3
    s_add_u32 s62, s62, s60
    s_mul_i32 s62, s62, 49152
    s_add_u32 s62, s62, s61
    s_add_u32 s72, s62, 7864320
    s_add_u32 s62, s75, 3
    s_and_b32 s62, s62, 3
    s_add_u32 s62, s62, s60
    s_mul_i32 s62, s62, 49152
    s_add_u32 s62, s62, s61
    s_add_u32 s73, s62, 7864320
    s_mul_i32 s92, s88, 49152
    s_add_u32 s92, s92, s61
    s_add_u32 s92, s92, 14155776
    s_waitcnt vmcnt(0)
    s_waitcnt vmcnt(8) lgkmcnt(0)
    s_barrier
    s_cmp_lg_u32 s75, 0
    s_cbranch_scc1 LH_f2
    v_lshlrev_b32 v6, 30, v0
    v_lshrrev_b32 v7, 2, v0
    v_lshl_or_b32 v6, v7, 26, v6
    v_mov_b32 v8, s76
    v_mov_b32 v9, s77
    s_lshl_b32 s60, s53, 11
    s_lshl_b32 s61, s54, 7
    s_add_u32 s60, s60, s61
    s_add_u32 s60, s60, 19709952
    buffer_store_dwordx2 v[8:9], v6, s[12:15], s60 offen sc1
LH_f2:
    s_or_b32 s60, s94, s75
    s_cmp_lg_u32 s60, 0
    s_cbranch_scc1 LH_nofw
    s_lshl_b32 s60, s91, 5
    s_add_u32 s60, s60, 19873792
    buffer_store_dwordx2 v[8:9], v6, s[12:15], s60 offen sc1
LH_nofw:
    s_bitcmp1_b32 s75, 1
    s_cbranch_scc1 LH_d2_v
    s_add_u32 m0, s90, 0
    s_add_u32 s64, s89, 4096
    buffer_load_dwordx4 v5, s[12:15], s64 offen offset:0 sc1 lds
    buffer_load_dwordx4 v5, s[12:15], s64 offen offset:1024 sc1 lds
    s_add_u32 m0, s90, 2048
    s_add_u32 s64, s89, 20480
    buffer_load_dwordx4 v5, s[12:15], s64 offen offset:0 sc1 lds
    buffer_load_dwordx4 v5, s[12:15], s64 offen offset:1024 sc1 lds
    s_add_u32 m0, s90, 4096
    s_add_u32 s64, s89, 36864
    buffer_load_dwordx4 v5, s[12:15], s64 offen offset:0 sc1 lds
    buffer_load_dwordx4 v5, s[12:15], s64 offen offset:1024 sc1 lds
    s_branch LH_d2_e
LH_d2_v:
    s_mov_b32 exec_lo, 0x000fffff
    s_mov_b32 exec_hi, 0x000fffff
    s_add_u32 m0, s90, 0
    s_add_u32 s64, s89, 20480
    buffer_load_dwordx4 v3, s[12:15], s64 offen sc1 lds
    s_add_u32 m0, s90, 1024
    s_add_u32 s64, s89, 21120
    buffer_load_dwordx4 v3, s[12:15], s64 offen sc1 lds
    s_add_u32 m0, s90, 2048
    s_add_u32 s64, s89, 21760
    buffer_load_dwordx4 v3, s[12:15], s64 offen sc1 lds
    s_add_u32 m0, s90, 3072
    s_add_u32 s64, s89, 22400
    buffer_load_dwordx4 v3, s[12:15], s64 offen sc1 lds
    s_add_u32 m0, s90, 4096
    s_add_u32 s64, s89, 23040
    buffer_load_dwordx4 v3, s[12:15], s64 offen sc1 lds
    s_add_u32 m0, s90, 5120
    s_add_u32 s64, s89, 23680
    buffer_load_dwordx4 v3, s[12:15], s64 offen sc1 lds
    s_add_u32 m0, s90, 6144
    s_add_u32 s64, s89, 24320
    buffer_load_dwordx4 v3, s[12:15], s64 offen sc1 lds
    s_add_u32 m0, s90, 7168
    s_add_u32 s64, s89, 24960
    buffer_load_dwordx4 v3, s[12:15], s64 offen sc1 lds
    s_mov_b64 exec, -1
LH_d2_e:
    s_waitcnt vmcnt(0)
    s_barrier
    s_bitcmp1_b32 s75, 1
    s_cbranch_scc1 LH_d3_v
    s_add_u32 m0, s90, 26624
    s_add_u32 s64, s89, 6144
    buffer_load_dwordx4 v5, s[12:15], s64 offen offset:0 sc1 lds
    buffer_load_dwordx4 v5, s[12:15], s64 offen offset:1024 sc1 lds
    s_add_u32 m0, s90, 28672
    s_add_u32 s64, s89, 22528
    buffer_load_dwordx4 v5, s[12:15], s64 offen offset:0 sc1 lds
    buffer_load_dwordx4 v5, s[12:15], s64 offen offset:1024 sc1 lds
    s_add_u32 m0, s90, 30720
    s_add_u32 s64, s89, 38912
    buffer_load_dwordx4 v5, s[12:15], s64 offen offset:0 sc1 lds
    buffer_load_dwordx4 v5, s[12:15], s64 offen offset:1024 sc1 lds
    s_branch LH_d3_e
LH_d3_v:
    s_mov_b32 exec_lo, 0x000fffff
    s_mov_b32 exec_hi, 0x000fffff
    s_add_u32 m0, s90, 26624
    s_add_u32 s64, s89, 30720
    buffer_load_dwordx4 v3, s[12:15], s64 offen sc1 lds
    s_add_u32 m0, s90, 27648
    s_add_u32 s64, s89, 31360
    buffer_load_dwordx4 v3, s[12:15], s64 offen sc1 lds
    s_add_u32 m0, s90, 28672
    s_add_u32 s64, s89, 32000
    buffer_load_dwordx4 v3, s[12:15], s64 offen sc1 lds
    s_add_u32 m0, s90, 29696
    s_add_u32 s64, s89, 32640
    buffer_load_dwordx4 v3, s[12:15], s64 offen sc1 lds
    s_add_u32 m0, s90, 30720
    s_add_u32 s64, s89, 33280
    buffer_load_dwordx4 v3, s[12:15], s64 offen sc1 lds
    s_add_u32 m0, s90, 31744
    s_add_u32 s64, s89, 33920
    buffer_load_dwordx4 v3, s[12:15], s64 offen sc1 lds
    s_add_u32 m0, s90, 32768
    s_add_u32 s64, s89, 34560
    buffer_load_dwordx4 v3, s[12:15], s64 offen sc1 lds
    s_add_u32 m0, s90, 33792
    s_add_u32 s64, s89, 35200
    buffer_load_dwordx4 v3, s[12:15], s64 offen sc1 lds
    s_mov_b64 exec, -1
LH_d3_e:
    s_waitcnt vmcnt(0)
    s_barrier
    s_bitcmp1_b32 s75, 1
    s_cbranch_scc1 LH_d4_v
    s_add_u32 m0, s90, 0
    s_add_u32 s64, s89, 8192
    buffer_load_dwordx4 v5, s[12:15], s64 offen offset:0 sc1 lds
    buffer_load_dwordx4 v5, s[12:15], s64 offen offset:1024 sc1 lds
    s_add_u32 m0, s90, 2048
    s_add_u32 s64, s89, 24576
    buffer_load_dwordx4 v5, s[12:15], s64 offen offset:0 sc1 lds
    buffer_load_dwordx4 v5, s[12:15], s64 offen offset:1024 sc1 lds
    s_add_u32 m0, s90, 4096
    s_add_u32 s64, s89, 40960
    buffer_load_dwordx4 v5, s[12:15], s64 offen offset:0 sc1 lds
    buffer_load_dwordx4 v5, s[12:15], s64 offen offset:1024 sc1 lds
    s_branch LH_d4_e
LH_d4_v:
    s_mov_b32 exec_lo, 0x000fffff
    s_mov_b32 exec_hi, 0x000fffff
    s_add_u32 m0, s90, 0
    s_add_u32 s64, s89, 40960
    buffer_load_dwordx4 v3, s[12:15], s64 offen sc1 lds
    s_add_u32 m0, s90, 1024
    s_add_u32 s64, s89, 41600
    buffer_load_dwordx4 v3, s[12:15], s64 offen sc1 lds
    s_add_u32 m0, s90, 2048
    s_add_u32 s64, s89, 42240
    buffer_load_dwordx4 v3, s[12:15], s64 offen sc1 lds
    s_add_u32 m0, s90, 3072
    s_add_u32 s64, s89, 42880
    buffer_load_dwordx4 v3, s[12:15], s64 offen sc1 lds
    s_add_u32 m0, s90, 4096
    s_add_u32 s64, s89, 43520
    buffer_load_dwordx4 v3, s[12:15], s64 offen sc1 lds
    s_add_u32 m0, s90, 5120
    s_add_u32 s64, s89, 44160
    buffer_load_dwordx4 v3, s[12:15], s64 offen sc1 lds
    s_add_u32 m0, s90, 6144
    s_add_u32 s64, s89, 44800
    buffer_load_dwordx4 v3, s[12:15], s64 offen sc1 lds
    s_add_u32 m0, s90, 7168
    s_add_u32 s64, s89, 45440
    buffer_load_dwordx4 v3, s[12:15], s64 offen sc1 lds
    s_mov_b64 exec, -1
LH_d4_e:
    v_mov_b32 v13, 53252
    s_cmp_lg_u32 s75, 0
    s_cbranch_scc1 LH_s2r
    s_mov_b32 s60, 19873792
    v_lshlrev_b32 v100, 7, v0
    v_and_b32 v101, 0x780, v100
    s_lshr_b32 s61, s87, 7
    s_lshl_b32 s61, s61, 11
    s_add_u32 s61, s61, 19709952
    v_add_u32 v102, s61, v101
    v_add_u32 v101, 19881984, v101
    v_cmp_gt_u32 vcc, 16, v0
    s_nop 1
    v_cndmask_b32 v101, v102, v101, vcc
    s_mov_b32 s58, 0x20000
LH_s2:
    buffer_load_dwordx2 v[96:97], v100, s[12:15], s60 offen sc1
    buffer_load_dwordx2 v[98:99], v101, s[12:15], 0 offen sc1
    s_waitcnt vmcnt(0)
    v_cmp_eq_u32 vcc, s76, v96
    v_cmp_eq_u32 s[62:63], s77, v97
    s_nop 0
    s_and_b64 vcc, vcc, s[62:63]
    v_cmp_eq_u32 s[62:63], s76, v98
    s_nop 0
    s_and_b64 vcc, vcc, s[62:63]
    v_cmp_eq_u32 s[62:63], s77, v99
    s_nop 0
    s_and_b64 vcc, vcc, s[62:63]
    s_cmp_eq_u64 vcc, exec
    s_cbranch_scc1 LH_s2_ok
    s_sleep 8
    s_sub_u32 s58, s58, 1
    s_cmp_lg_u32 s58, 0
    s_cbranch_scc1 LH_s2
LH_s2_ok:
    v_mov_b32 v6, 1
    ds_write_b32 v13, v6
    s_branch LH_s2d
LH_s2r:
    s_mov_b32 s58, 0x400000
LH_s2l:
    ds_read_b32 v6, v13
    s_waitcnt lgkmcnt(0)
    v_readfirstlane_b32 s60, v6
    s_nop 0
    s_cmp_lg_u32 s60, 0
    s_cbranch_scc1 LH_s2d
    s_sleep 2
    s_sub_u32 s58, s58, 1
    s_cmp_lg_u32 s58, 0
    s_cbranch_scc1 LH_s2l
LH_s2d:
    s_waitcnt lgkmcnt(0)
    s_add_u32 s64, s92, 0
    buffer_load_dwordx4 v[96:99], v5, s[12:15], s64 offen sc1
    s_add_u32 s64, s92, 49152
    buffer_load_dwordx4 v[100:103], v5, s[12:15], s64 offen sc1
    s_add_u32 s64, s92, 98304
    buffer_load_dwordx4 v[104:107], v5, s[12:15], s64 offen sc1
    s_add_u32 s64, s92, 147456
    buffer_load_dwordx4 v[108:111], v5, s[12:15], s64 offen sc1
    s_add_u32 s64, s92, 196608
    buffer_load_dwordx4 v[112:115], v5, s[12:15], s64 offen sc1
    s_add_u32 s64, s70, 0
    buffer_load_dwordx4 v[116:119], v5, s[12:15], s64 offen sc1
    s_add_u32 s64, s71, 0
    buffer_load_dwordx4 v[120:123], v5, s[12:15], s64 offen sc1
    s_add_u32 s64, s72, 0
    buffer_load_dwordx4 v[124:127], v5, s[12:15], s64 offen sc1
    s_add_u32 s64, s73, 0
    buffer_load_dwordx4 v[128:131], v5, s[12:15], s64 offen sc1
    s_add_u32 s64, s92, 1024
    buffer_load_dwordx4 v[132:135], v5, s[12:15], s64 offen sc1
    s_add_u32 s64, s92, 50176
    buffer_load_dwordx4 v[136:139], v5, s[12:15], s64 offen sc1
    s_add_u32 s64, s92, 99328
    buffer_load_dwordx4 v[140:143], v5, s[12:15], s64 offen sc1
    s_add_u32 s64, s92, 148480
    buffer_load_dwordx4 v[144:147], v5, s[12:15], s64 offen sc1
    s_add_u32 s64, s92, 197632
    buffer_load_dwordx4 v[148:151], v5, s[12:15], s64 offen sc1
    s_add_u32 s64, s70, 1024
    buffer_load_dwordx4 v[152:155], v5, s[12:15], s64 offen sc1
    s_add_u32 s64, s71, 1024
    buffer_load_dwordx4 v[156:159], v5, s[12:15], s64 offen sc1
    s_add_u32 s64, s72, 1024
    buffer_load_dwordx4 v[160:163], v5, s[12:15], s64 offen sc1
    s_add_u32 s64, s73, 1024
    buffer_load_dwordx4 v[164:167], v5, s[12:15], s64 offen sc1
    s_add_u32 s64, s92, 2048
    buffer_load_dwordx4 v[168:171], v5, s[12:15], s64 offen sc1
    s_add_u32 s64, s92, 51200
    buffer_load_dwordx4 v[172:175], v5, s[12:15], s64 offen sc1
    s_add_u32 s64, s92, 100352
    buffer_load_dwordx4 v[176:179], v5, s[12:15], s64 offen sc1
    s_add_u32 s64, s92, 149504
    buffer_load_dwordx4 v[180:183], v5, s[12:15], s64 offen sc1
    s_add_u32 s64, s92, 198656
    buffer_load_dwordx4 v[184:187], v5, s[12:15], s64 offen sc1
    s_add_u32 s64, s70, 2048
    buffer_load_dwordx4 v[188:191], v5, s[12:15], s64 offen sc1
    s_add_u32 s64, s71, 2048
    buffer_load_dwordx4 v[192:195], v5, s[12:15], s64 offen sc1
    s_add_u32 s64, s72, 2048
    buffer_load_dwordx4 v[196:199], v5, s[12:15], s64 offen sc1
    s_add_u32 s64, s73, 2048
    buffer_load_dwordx4 v[200:203], v5, s[12:15], s64 offen sc1
    v_and_b32 v13, 15, v0
    v_lshlrev_b32 v13, 2, v13
    s_lshl_b32 s60, s75, 4
    s_add_u32 s60, s60, s87
    s_lshl_b32 s60, s60, 2
    s_add_u32 s60, s60, 19570688
    buffer_load_dword v4, v13, s[12:15], s60 offen sc1
    s_waitcnt vmcnt(28)
    s_barrier
    s_bitcmp1_b32 s75, 1
    s_cbranch_scc1 LH_d5_v
    s_add_u32 m0, s90, 26624
    s_add_u32 s64, s89, 10240
    buffer_load_dwordx4 v5, s[12:15], s64 offen offset:0 sc1 lds
    buffer_load_dwordx4 v5, s[12:15], s64 offen offset:1024 sc1 lds
    s_add_u32 m0, s90, 28672
    s_add_u32 s64, s89, 26624
    buffer_load_dwordx4 v5, s[12:15], s64 offen offset:0 sc1 lds
    buffer_load_dwordx4 v5, s[12:15], s64 offen offset:1024 sc1 lds
    s_add_u32 m0, s90, 30720
    s_add_u32 s64, s89, 43008
    buffer_load_dwordx4 v5, s[12:15], s64 offen offset:0 sc1 lds
    buffer_load_dwordx4 v5, s[12:15], s64 offen offset:1024 sc1 lds
    s_branch LH_d5_e
LH_d5_v:
    s_mov_b32 exec_lo, 0x000fffff
    s_mov_b32 exec_hi, 0x000fffff
    s_add_u32 m0, s90, 26624
    s_add_u32 s64, s89, 51200
    buffer_load_dwordx4 v3, s[12:15], s64 offen sc1 lds
    s_add_u32 m0, s90, 27648
    s_add_u32 s64, s89, 51840
    buffer_load_dwordx4 v3, s[12:15], s64 offen sc1 lds
    s_add_u32 m0, s90, 28672
    s_add_u32 s64, s89, 52480
    buffer_load_dwordx4 v3, s[12:15], s64 offen sc1 lds
    s_add_u32 m0, s90, 29696
    s_add_u32 s64, s89, 53120
    buffer_load_dwordx4 v3, s[12:15], s64 offen sc1 lds
    s_add_u32 m0, s90, 30720
    s_add_u32 s64, s89, 53760
    buffer_load_dwordx4 v3, s[12:15], s64 offen sc1 lds
    s_add_u32 m0, s90, 31744
    s_add_u32 s64, s89, 54400
    buffer_load_dwordx4 v3, s[12:15], s64 offen sc1 lds
    s_add_u32 m0, s90, 32768
    s_add_u32 s64, s89, 55040
    buffer_load_dwordx4 v3, s[12:15], s64 offen sc1 lds
    s_add_u32 m0, s90, 33792
    s_add_u32 s64, s89, 55680
    buffer_load_dwordx4 v3, s[12:15], s64 offen sc1 lds
    s_mov_b64 exec, -1
LH_d5_e:
    s_waitcnt vmcnt(25)
    s_setprio 0
    v_mfma_f32_16x16x32_bf16 v[16:19], v[96:99], v[116:119], v[204:207]
    v_mfma_f32_16x16x32_bf16 v[20:23], v[96:99], v[120:123], 0
    v_mfma_f32_16x16x32_bf16 v[24:27], v[96:99], v[124:127], 0
    v_mfma_f32_16x16x32_bf16 v[28:31], v[96:99], v[128:131], 0
    v_mfma_f32_16x16x32_bf16 v[32:35], v[100:103], v[116:119], v[208:211]
    v_mfma_f32_16x16x32_bf16 v[36:39], v[100:103], v[120:123], 0
    v_mfma_f32_16x16x32_bf16 v[40:43], v[100:103], v[124:127], 0
    v_mfma_f32_16x16x32_bf16 v[44:47], v[100:103], v[128:131], 0
    v_mfma_f32_16x16x32_bf16 v[48:51], v[104:107], v[116:119], v[212:215]
    v_mfma_f32_16x16x32_bf16 v[52:55], v[104:107], v[120:123], 0
    v_mfma_f32_16x16x32_bf16 v[56:59], v[104:107], v[124:127], 0
    v_mfma_f32_16x16x32_bf16 v[60:63], v[104:107], v[128:131], 0
    v_mfma_f32_16x16x32_bf16 v[64:67], v[108:111], v[116:119], v[216:219]
    v_mfma_f32_16x16x32_bf16 v[68:71], v[108:111], v[120:123], 0
    v_mfma_f32_16x16x32_bf16 v[72:75], v[108:111], v[124:127], 0
    v_mfma_f32_16x16x32_bf16 v[76:79], v[108:111], v[128:131], 0
    v_mfma_f32_16x16x32_bf16 v[80:83], v[112:115], v[116:119], v[220:223]
    v_mfma_f32_16x16x32_bf16 v[84:87], v[112:115], v[120:123], 0
    v_mfma_f32_16x16x32_bf16 v[88:91], v[112:115], v[124:127], 0
    v_mfma_f32_16x16x32_bf16 v[92:95], v[112:115], v[128:131], 0
    s_setprio 3
    s_add_u32 s64, s92, 3072
    buffer_load_dwordx4 v[96:99], v5, s[12:15], s64 offen sc1
    s_add_u32 s64, s92, 52224
    buffer_load_dwordx4 v[100:103], v5, s[12:15], s64 offen sc1
    s_add_u32 s64, s92, 101376
    buffer_load_dwordx4 v[104:107], v5, s[12:15], s64 offen sc1
    s_add_u32 s64, s92, 150528
    buffer_load_dwordx4 v[108:111], v5, s[12:15], s64 offen sc1
    s_add_u32 s64, s92, 199680
    buffer_load_dwordx4 v[112:115], v5, s[12:15], s64 offen sc1
    s_add_u32 s64, s70, 3072
    buffer_load_dwordx4 v[116:119], v5, s[12:15], s64 offen sc1
    s_add_u32 s64, s71, 3072
    buffer_load_dwordx4 v[120:123], v5, s[12:15], s64 offen sc1
    s_add_u32 s64, s72, 3072
    buffer_load_dwordx4 v[124:127], v5, s[12:15], s64 offen sc1
    s_add_u32 s64, s73, 3072
    buffer_load_dwordx4 v[128:131], v5, s[12:15], s64 offen sc1
    s_waitcnt vmcnt(25)
    s_setprio 0
    v_mfma_f32_16x16x32_bf16 v[16:19], v[132:135], v[152:155], v[16:19]
    v_mfma_f32_16x16x32_bf16 v[20:23], v[132:135], v[156:159], v[20:23]
    v_mfma_f32_16x16x32_bf16 v[24:27], v[132:135], v[160:163], v[24:27]
    v_mfma_f32_16x16x32_bf16 v[28:31], v[132:135], v[164:167], v[28:31]
    v_mfma_f32_16x16x32_bf16 v[32:35], v[136:139], v[152:155], v[32:35]
    v_mfma_f32_16x16x32_bf16 v[36:39], v[136:139], v[156:159], v[36:39]
    v_mfma_f32_16x16x32_bf16 v[40:43], v[136:139], v[160:163], v[40:43]
    v_mfma_f32_16x16x32_bf16 v[44:47], v[136:139], v[164:167], v[44:47]
    v_mfma_f32_16x16x32_bf16 v[48:51], v[140:143], v[152:155], v[48:51]
    v_mfma_f32_16x16x32_bf16 v[52:55], v[140:143], v[156:159], v[52:55]
    v_mfma_f32_16x16x32_bf16 v[56:59], v[140:143], v[160:163], v[56:59]
    v_mfma_f32_16x16x32_bf16 v[60:63], v[140:143], v[164:167], v[60:63]
    v_mfma_f32_16x16x32_bf16 v[64:67], v[144:147], v[152:155], v[64:67]
    v_mfma_f32_16x16x32_bf16 v[68:71], v[144:147], v[156:159], v[68:71]
    v_mfma_f32_16x16x32_bf16 v[72:75], v[144:147], v[160:163], v[72:75]
    v_mfma_f32_16x16x32_bf16 v[76:79], v[144:147], v[164:167], v[76:79]
    v_mfma_f32_16x16x32_bf16 v[80:83], v[148:151], v[152:155], v[80:83]
    v_mfma_f32_16x16x32_bf16 v[84:87], v[148:151], v[156:159], v[84:87]
    v_mfma_f32_16x16x32_bf16 v[88:91], v[148:151], v[160:163], v[88:91]
    v_mfma_f32_16x16x32_bf16 v[92:95], v[148:151], v[164:167], v[92:95]
    s_setprio 3
    s_add_u32 s64, s92, 4096
    buffer_load_dwordx4 v[132:135], v5, s[12:15], s64 offen sc1
    s_add_u32 s64, s92, 53248
    buffer_load_dwordx4 v[136:139], v5, s[12:15], s64 offen sc1
    s_add_u32 s64, s92, 102400
    buffer_load_dwordx4 v[140:143], v5, s[12:15], s64 offen sc1
    s_add_u32 s64, s92, 151552
    buffer_load_dwordx4 v[144:147], v5, s[12:15], s64 offen sc1
    s_add_u32 s64, s92, 200704
    buffer_load_dwordx4 v[148:151], v5, s[12:15], s64 offen sc1
    s_add_u32 s64, s70, 4096
    buffer_load_dwordx4 v[152:155], v5, s[12:15], s64 offen sc1
    s_add_u32 s64, s71, 4096
    buffer_load_dwordx4 v[156:159], v5, s[12:15], s64 offen sc1
    s_add_u32 s64, s72, 4096
    buffer_load_dwordx4 v[160:163], v5, s[12:15], s64 offen sc1
    s_add_u32 s64, s73, 4096
    buffer_load_dwordx4 v[164:167], v5, s[12:15], s64 offen sc1
    s_waitcnt vmcnt(25)
    s_setprio 0
    v_mfma_f32_16x16x32_bf16 v[16:19], v[168:171], v[188:191], v[16:19]
    v_mfma_f32_16x16x32_bf16 v[20:23], v[168:171], v[192:195], v[20:23]
    v_mfma_f32_16x16x32_bf16 v[24:27], v[168:171], v[196:199], v[24:27]
    v_mfma_f32_16x16x32_bf16 v[28:31], v[168:171], v[200:203], v[28:31]
    v_mfma_f32_16x16x32_bf16 v[32:35], v[172:175], v[188:191], v[32:35]
    v_mfma_f32_16x16x32_bf16 v[36:39], v[172:175], v[192:195], v[36:39]
    v_mfma_f32_16x16x32_bf16 v[40:43], v[172:175], v[196:199], v[40:43]
    v_mfma_f32_16x16x32_bf16 v[44:47], v[172:175], v[200:203], v[44:47]
    v_mfma_f32_16x16x32_bf16 v[48:51], v[176:179], v[188:191], v[48:51]
    v_mfma_f32_16x16x32_bf16 v[52:55], v[176:179], v[192:195], v[52:55]
    v_mfma_f32_16x16x32_bf16 v[56:59], v[176:179], v[196:199], v[56:59]
    v_mfma_f32_16x16x32_bf16 v[60:63], v[176:179], v[200:203], v[60:63]
    v_mfma_f32_16x16x32_bf16 v[64:67], v[180:183], v[188:191], v[64:67]
    v_mfma_f32_16x16x32_bf16 v[68:71], v[180:183], v[192:195], v[68:71]
    v_mfma_f32_16x16x32_bf16 v[72:75], v[180:183], v[196:199], v[72:75]
    v_mfma_f32_16x16x32_bf16 v[76:79], v[180:183], v[200:203], v[76:79]
    v_mfma_f32_16x16x32_bf16 v[80:83], v[184:187], v[188:191], v[80:83]
    v_mfma_f32_16x16x32_bf16 v[84:87], v[184:187], v[192:195], v[84:87]
    v_mfma_f32_16x16x32_bf16 v[88:91], v[184:187], v[196:199], v[88:91]
    v_mfma_f32_16x16x32_bf16 v[92:95], v[184:187], v[200:203], v[92:95]
    s_setprio 3
    s_add_u32 s64, s92, 5120
    buffer_load_dwordx4 v[168:171], v5, s[12:15], s64 offen sc1
    s_add_u32 s64, s92, 54272
    buffer_load_dwordx4 v[172:175], v5, s[12:15], s64 offen sc1
    s_add_u32 s64, s92, 103424
    buffer_load_dwordx4 v[176:179], v5, s[12:15], s64 offen sc1
    s_add_u32 s64, s92, 152576
    buffer_load_dwordx4 v[180:183], v5, s[12:15], s64 offen sc1
    s_add_u32 s64, s92, 201728
    buffer_load_dwordx4 v[184:187], v5, s[12:15], s64 offen sc1
    s_add_u32 s64, s70, 5120
    buffer_load_dwordx4 v[188:191], v5, s[12:15], s64 offen sc1
    s_add_u32 s64, s71, 5120
    buffer_load_dwordx4 v[192:195], v5, s[12:15], s64 offen sc1
    s_add_u32 s64, s72, 5120
    buffer_load_dwordx4 v[196:199], v5, s[12:15], s64 offen sc1
    s_add_u32 s64, s73, 5120
    buffer_load_dwordx4 v[200:203], v5, s[12:15], s64 offen sc1
    s_waitcnt vmcnt(27)
    s_barrier
    s_bitcmp1_b32 s75, 1
    s_cbranch_scc1 LH_d6_v
    s_add_u32 m0, s90, 0
    s_add_u32 s64, s89, 12288
    buffer_load_dwordx4 v5, s[12:15], s64 offen offset:0 sc1 lds
    buffer_load_dwordx4 v5, s[12:15], s64 offen offset:1024 sc1 lds
    s_add_u32 m0, s90, 2048
    s_add_u32 s64, s89, 28672
    buffer_load_dwordx4 v5, s[12:15], s64 offen offset:0 sc1 lds
    buffer_load_dwordx4 v5, s[12:15], s64 offen offset:1024 sc1 lds
    s_add_u32 m0, s90, 4096
    s_add_u32 s64, s89, 45056
    buffer_load_dwordx4 v5, s[12:15], s64 offen offset:0 sc1 lds
    buffer_load_dwordx4 v5, s[12:15], s64 offen offset:1024 sc1 lds
    s_branch LH_d6_e
LH_d6_v:
    s_mov_b32 exec_lo, 0x000fffff
    s_mov_b32 exec_hi, 0x000fffff
    s_add_u32 m0, s90, 0
    s_add_u32 s64, s89, 61440
    buffer_load_dwordx4 v3, s[12:15], s64 offen sc1 lds
    s_add_u32 m0, s90, 1024
    s_add_u32 s64, s89, 62080
    buffer_load_dwordx4 v3, s[12:15], s64 offen sc1 lds
    s_add_u32 m0, s90, 2048
    s_add_u32 s64, s89, 62720
    buffer_load_dwordx4 v3, s[12:15], s64 offen sc1 lds
    s_add_u32 m0, s90, 3072
    s_add_u32 s64, s89, 63360
    buffer_load_dwordx4 v3, s[12:15], s64 offen sc1 lds
    s_add_u32 m0, s90, 4096
    s_add_u32 s64, s89, 64000
    buffer_load_dwordx4 v3, s[12:15], s64 offen sc1 lds
    s_add_u32 m0, s90, 5120
    s_add_u32 s64, s89, 64640
    buffer_load_dwordx4 v3, s[12:15], s64 offen sc1 lds
    s_add_u32 m0, s90, 6144
    s_add_u32 s64, s89, 65280
    buffer_load_dwordx4 v3, s[12:15], s64 offen sc1 lds
    s_add_u32 m0, s90, 7168
    s_add_u32 s64, s89, 65920
    buffer_load_dwordx4 v3, s[12:15], s64 offen sc1 lds
    s_mov_b64 exec, -1
LH_d6_e:
    s_waitcnt vmcnt(24)
    s_setprio 0
    v_mfma_f32_16x16x32_bf16 v[16:19], v[96:99], v[116:119], v[16:19]
    v_mfma_f32_16x16x32_bf16 v[20:23], v[96:99], v[120:123], v[20:23]
    v_mfma_f32_16x16x32_bf16 v[24:27], v[96:99], v[124:127], v[24:27]
    v_mfma_f32_16x16x32_bf16 v[28:31], v[96:99], v[128:131], v[28:31]
    v_mfma_f32_16x16x32_bf16 v[32:35], v[100:103], v[116:119], v[32:35]
    v_mfma_f32_16x16x32_bf16 v[36:39], v[100:103], v[120:123], v[36:39]
    v_mfma_f32_16x16x32_bf16 v[40:43], v[100:103], v[124:127], v[40:43]
    v_mfma_f32_16x16x32_bf16 v[44:47], v[100:103], v[128:131], v[44:47]
    v_mfma_f32_16x16x32_bf16 v[48:51], v[104:107], v[116:119], v[48:51]
    v_mfma_f32_16x16x32_bf16 v[52:55], v[104:107], v[120:123], v[52:55]
    v_mfma_f32_16x16x32_bf16 v[56:59], v[104:107], v[124:127], v[56:59]
    v_mfma_f32_16x16x32_bf16 v[60:63], v[104:107], v[128:131], v[60:63]
    v_mfma_f32_16x16x32_bf16 v[64:67], v[108:111], v[116:119], v[64:67]
    v_mfma_f32_16x16x32_bf16 v[68:71], v[108:111], v[120:123], v[68:71]
    v_mfma_f32_16x16x32_bf16 v[72:75], v[108:111], v[124:127], v[72:75]
    v_mfma_f32_16x16x32_bf16 v[76:79], v[108:111], v[128:131], v[76:79]
    v_mfma_f32_16x16x32_bf16 v[80:83], v[112:115], v[116:119], v[80:83]
    v_mfma_f32_16x16x32_bf16 v[84:87], v[112:115], v[120:123], v[84:87]
    v_mfma_f32_16x16x32_bf16 v[88:91], v[112:115], v[124:127], v[88:91]
    v_mfma_f32_16x16x32_bf16 v[92:95], v[112:115], v[128:131], v[92:95]
    s_setprio 3
    s_add_u32 s64, s92, 6144
    buffer_load_dwordx4 v[96:99], v5, s[12:15], s64 offen sc1
    s_add_u32 s64, s92, 55296
    buffer_load_dwordx4 v[100:103], v5, s[12:15], s64 offen sc1
    s_add_u32 s64, s92, 104448
    buffer_load_dwordx4 v[104:107], v5, s[12:15], s64 offen sc1
    s_add_u32 s64, s92, 153600
    buffer_load_dwordx4 v[108:111], v5, s[12:15], s64 offen sc1
    s_add_u32 s64, s92, 202752
    buffer_load_dwordx4 v[112:115], v5, s[12:15], s64 offen sc1
    s_add_u32 s64, s70, 6144
    buffer_load_dwordx4 v[116:119], v5, s[12:15], s64 offen sc1
    s_add_u32 s64, s71, 6144
    buffer_load_dwordx4 v[120:123], v5, s[12:15], s64 offen sc1
    s_add_u32 s64, s72, 6144
    buffer_load_dwordx4 v[124:127], v5, s[12:15], s64 offen sc1
    s_add_u32 s64, s73, 6144
    buffer_load_dwordx4 v[128:131], v5, s[12:15], s64 offen sc1
    s_waitcnt vmcnt(24)
    s_setprio 0
    v_mfma_f32_16x16x32_bf16 v[16:19], v[132:135], v[152:155], v[16:19]
    v_mfma_f32_16x16x32_bf16 v[20:23], v[132:135], v[156:159], v[20:23]
    v_mfma_f32_16x16x32_bf16 v[24:27], v[132:135], v[160:163], v[24:27]
    v_mfma_f32_16x16x32_bf16 v[28:31], v[132:135], v[164:167], v[28:31]
    v_mfma_f32_16x16x32_bf16 v[32:35], v[136:139], v[152:155], v[32:35]
    v_mfma_f32_16x16x32_bf16 v[36:39], v[136:139], v[156:159], v[36:39]
    v_mfma_f32_16x16x32_bf16 v[40:43], v[136:139], v[160:163], v[40:43]
    v_mfma_f32_16x16x32_bf16 v[44:47], v[136:139], v[164:167], v[44:47]
    v_mfma_f32_16x16x32_bf16 v[48:51], v[140:143], v[152:155], v[48:51]
    v_mfma_f32_16x16x32_bf16 v[52:55], v[140:143], v[156:159], v[52:55]
    v_mfma_f32_16x16x32_bf16 v[56:59], v[140:143], v[160:163], v[56:59]
    v_mfma_f32_16x16x32_bf16 v[60:63], v[140:143], v[164:167], v[60:63]
    v_mfma_f32_16x16x32_bf16 v[64:67], v[144:147], v[152:155], v[64:67]
    v_mfma_f32_16x16x32_bf16 v[68:71], v[144:147], v[156:159], v[68:71]
    v_mfma_f32_16x16x32_bf16 v[72:75], v[144:147], v[160:163], v[72:75]
    v_mfma_f32_16x16x32_bf16 v[76:79], v[144:147], v[164:167], v[76:79]
    v_mfma_f32_16x16x32_bf16 v[80:83], v[148:151], v[152:155], v[80:83]
    v_mfma_f32_16x16x32_bf16 v[84:87], v[148:151], v[156:159], v[84:87]
    v_mfma_f32_16x16x32_bf16 v[88:91], v[148:151], v[160:163], v[88:91]
    v_mfma_f32_16x16x32_bf16 v[92:95], v[148:151], v[164:167], v[92:95]
    s_setprio 3
    s_add_u32 s64, s92, 7168
    buffer_load_dwordx4 v[132:135], v5, s[12:15], s64 offen sc1
    s_add_u32 s64, s92, 56320
    buffer_load_dwordx4 v[136:139], v5, s[12:15], s64 offen sc1
    s_add_u32 s64, s92, 105472
    buffer_load_dwordx4 v[140:143], v5, s[12:15], s64 offen sc1
    s_add_u32 s64, s92, 154624
    buffer_load_dwordx4 v[144:147], v5, s[12:15], s64 offen sc1
    s_add_u32 s64, s92, 203776
    buffer_load_dwordx4 v[148:151], v5, s[12:15], s64 offen sc1
    s_add_u32 s64, s70, 7168
    buffer_load_dwordx4 v[152:155], v5, s[12:15], s64 offen sc1
    s_add_u32 s64, s71, 7168
    buffer_load_dwordx4 v[156:159], v5, s[12:15], s64 offen sc1
    s_add_u32 s64, s72, 7168
    buffer_load_dwordx4 v[160:163], v5, s[12:15], s64 offen sc1
    s_add_u32 s64, s73, 7168
    buffer_load_dwordx4 v[164:167], v5, s[12:15], s64 offen sc1
    s_waitcnt vmcnt(18)
    s_barrier
    s_bitcmp1_b32 s75, 1
    s_cbranch_scc1 LH_d7_v
    s_add_u32 m0, s90, 26624
    s_add_u32 s64, s89, 14336
    buffer_load_dwordx4 v5, s[12:15], s64 offen offset:0 sc1 lds
    buffer_load_dwordx4 v5, s[12:15], s64 offen offset:1024 sc1 lds
    s_add_u32 m0, s90, 28672
    s_add_u32 s64, s89, 30720
    buffer_load_dwordx4 v5, s[12:15], s64 offen offset:0 sc1 lds
    buffer_load_dwordx4 v5, s[12:15], s64 offen offset:1024 sc1 lds
    s_add_u32 m0, s90, 30720
    s_add_u32 s64, s89, 47104
    buffer_load_dwordx4 v5, s[12:15], s64 offen offset:0 sc1 lds
    buffer_load_dwordx4 v5, s[12:15], s64 offen offset:1024 sc1 lds
    s_branch LH_d7_e
LH_d7_v:
    s_mov_b32 exec_lo, 0x000fffff
    s_mov_b32 exec_hi, 0x000fffff
    s_add_u32 m0, s90, 26624
    s_add_u32 s64, s89, 71680
    buffer_load_dwordx4 v3, s[12:15], s64 offen sc1 lds
    s_add_u32 m0, s90, 27648
    s_add_u32 s64, s89, 72320
    buffer_load_dwordx4 v3, s[12:15], s64 offen sc1 lds
    s_add_u32 m0, s90, 28672
    s_add_u32 s64, s89, 72960
    buffer_load_dwordx4 v3, s[12:15], s64 offen sc1 lds
    s_add_u32 m0, s90, 29696
    s_add_u32 s64, s89, 73600
    buffer_load_dwordx4 v3, s[12:15], s64 offen sc1 lds
    s_add_u32 m0, s90, 30720
    s_add_u32 s64, s89, 74240
    buffer_load_dwordx4 v3, s[12:15], s64 offen sc1 lds
    s_add_u32 m0, s90, 31744
    s_add_u32 s64, s89, 74880
    buffer_load_dwordx4 v3, s[12:15], s64 offen sc1 lds
    s_add_u32 m0, s90, 32768
    s_add_u32 s64, s89, 75520
    buffer_load_dwordx4 v3, s[12:15], s64 offen sc1 lds
    s_add_u32 m0, s90, 33792
    s_add_u32 s64, s89, 76160
    buffer_load_dwordx4 v3, s[12:15], s64 offen sc1 lds
    s_mov_b64 exec, -1
LH_d7_e:
    s_waitcnt vmcnt(30)
    s_setprio 0
    v_mfma_f32_16x16x32_bf16 v[16:19], v[168:171], v[188:191], v[16:19]
    v_mfma_f32_16x16x32_bf16 v[20:23], v[168:171], v[192:195], v[20:23]
    v_mfma_f32_16x16x32_bf16 v[24:27], v[168:171], v[196:199], v[24:27]
    v_mfma_f32_16x16x32_bf16 v[28:31], v[168:171], v[200:203], v[28:31]
    v_mfma_f32_16x16x32_bf16 v[32:35], v[172:175], v[188:191], v[32:35]
    v_mfma_f32_16x16x32_bf16 v[36:39], v[172:175], v[192:195], v[36:39]
    v_mfma_f32_16x16x32_bf16 v[40:43], v[172:175], v[196:199], v[40:43]
    v_mfma_f32_16x16x32_bf16 v[44:47], v[172:175], v[200:203], v[44:47]
    v_mfma_f32_16x16x32_bf16 v[48:51], v[176:179], v[188:191], v[48:51]
    v_mfma_f32_16x16x32_bf16 v[52:55], v[176:179], v[192:195], v[52:55]
    v_mfma_f32_16x16x32_bf16 v[56:59], v[176:179], v[196:199], v[56:59]
    v_mfma_f32_16x16x32_bf16 v[60:63], v[176:179], v[200:203], v[60:63]
    v_mfma_f32_16x16x32_bf16 v[64:67], v[180:183], v[188:191], v[64:67]
    v_mfma_f32_16x16x32_bf16 v[68:71], v[180:183], v[192:195], v[68:71]
    v_mfma_f32_16x16x32_bf16 v[72:75], v[180:183], v[196:199], v[72:75]
    v_mfma_f32_16x16x32_bf16 v[76:79], v[180:183], v[200:203], v[76:79]
    v_mfma_f32_16x16x32_bf16 v[80:83], v[184:187], v[188:191], v[80:83]
    v_mfma_f32_16x16x32_bf16 v[84:87], v[184:187], v[192:195], v[84:87]
    v_mfma_f32_16x16x32_bf16 v[88:91], v[184:187], v[196:199], v[88:91]
    v_mfma_f32_16x16x32_bf16 v[92:95], v[184:187], v[200:203], v[92:95]
    s_setprio 3
    s_add_u32 s64, s92, 8192
    buffer_load_dwordx4 v[168:171], v5, s[12:15], s64 offen sc1
    s_add_u32 s64, s92, 57344
    buffer_load_dwordx4 v[172:175], v5, s[12:15], s64 offen sc1
    s_add_u32 s64, s92, 106496
    buffer_load_dwordx4 v[176:179], v5, s[12:15], s64 offen sc1
    s_add_u32 s64, s92, 155648
    buffer_load_dwordx4 v[180:183], v5, s[12:15], s64 offen sc1
    s_add_u32 s64, s92, 204800
    buffer_load_dwordx4 v[184:187], v5, s[12:15], s64 offen sc1
    s_add_u32 s64, s70, 8192
    buffer_load_dwordx4 v[188:191], v5, s[12:15], s64 offen sc1
    s_add_u32 s64, s71, 8192
    buffer_load_dwordx4 v[192:195], v5, s[12:15], s64 offen sc1
    s_add_u32 s64, s72, 8192
    buffer_load_dwordx4 v[196:199], v5, s[12:15], s64 offen sc1
    s_add_u32 s64, s73, 8192
    buffer_load_dwordx4 v[200:203], v5, s[12:15], s64 offen sc1
    s_waitcnt vmcnt(24)
    s_setprio 0
    v_mfma_f32_16x16x32_bf16 v[16:19], v[96:99], v[116:119], v[16:19]
    v_mfma_f32_16x16x32_bf16 v[20:23], v[96:99], v[120:123], v[20:23]
    v_mfma_f32_16x16x32_bf16 v[24:27], v[96:99], v[124:127], v[24:27]
    v_mfma_f32_16x16x32_bf16 v[28:31], v[96:99], v[128:131], v[28:31]
    v_mfma_f32_16x16x32_bf16 v[32:35], v[100:103], v[116:119], v[32:35]
    v_mfma_f32_16x16x32_bf16 v[36:39], v[100:103], v[120:123], v[36:39]
    v_mfma_f32_16x16x32_bf16 v[40:43], v[100:103], v[124:127], v[40:43]
    v_mfma_f32_16x16x32_bf16 v[44:47], v[100:103], v[128:131], v[44:47]
    v_mfma_f32_16x16x32_bf16 v[48:51], v[104:107], v[116:119], v[48:51]
    v_mfma_f32_16x16x32_bf16 v[52:55], v[104:107], v[120:123], v[52:55]
    v_mfma_f32_16x16x32_bf16 v[56:59], v[104:107], v[124:127], v[56:59]
    v_mfma_f32_16x16x32_bf16 v[60:63], v[104:107], v[128:131], v[60:63]
    v_mfma_f32_16x16x32_bf16 v[64:67], v[108:111], v[116:119], v[64:67]
    v_mfma_f32_16x16x32_bf16 v[68:71], v[108:111], v[120:123], v[68:71]
    v_mfma_f32_16x16x32_bf16 v[72:75], v[108:111], v[124:127], v[72:75]
    v_mfma_f32_16x16x32_bf16 v[76:79], v[108:111], v[128:131], v[76:79]
    v_mfma_f32_16x16x32_bf16 v[80:83], v[112:115], v[116:119], v[80:83]
    v_mfma_f32_16x16x32_bf16 v[84:87], v[112:115], v[120:123], v[84:87]
    v_mfma_f32_16x16x32_bf16 v[88:91], v[112:115], v[124:127], v[88:91]
    v_mfma_f32_16x16x32_bf16 v[92:95], v[112:115], v[128:131], v[92:95]
    s_setprio 3
    s_add_u32 s64, s92, 9216
    buffer_load_dwordx4 v[96:99], v5, s[12:15], s64 offen sc1
    s_add_u32 s64, s92, 58368
    buffer_load_dwordx4 v[100:103], v5, s[12:15], s64 offen sc1
    s_add_u32 s64, s92, 107520
    buffer_load_dwordx4 v[104:107], v5, s[12:15], s64 offen sc1
    s_add_u32 s64, s92, 156672
    buffer_load_dwordx4 v[108:111], v5, s[12:15], s64 offen sc1
    s_add_u32 s64, s92, 205824
    buffer_load_dwordx4 v[112:115], v5, s[12:15], s64 offen sc1
    s_add_u32 s64, s70, 9216
    buffer_load_dwordx4 v[116:119], v5, s[12:15], s64 offen sc1
    s_add_u32 s64, s71, 9216
    buffer_load_dwordx4 v[120:123], v5, s[12:15], s64 offen sc1
    s_add_u32 s64, s72, 9216
    buffer_load_dwordx4 v[124:127], v5, s[12:15], s64 offen sc1
    s_add_u32 s64, s73, 9216
    buffer_load_dwordx4 v[128:131], v5, s[12:15], s64 offen sc1
    s_waitcnt vmcnt(18)
    s_barrier
    s_mul_i32 s85, s88, 20480
    s_mul_i32 s61, s75, 5120
    s_add_u32 s85, s85, s61
    s_add_u32 s85, s85, 16121856
    s_mul_i32 s86, s75, 25600
    s_add_u32 s86, s86, 53504
    v_add_u32 v12, s86, v5
    s_add_u32 s64, s85, 0
    s_add_u32 m0, s86, 0
    s_nop 0
    buffer_load_dwordx4 v5, s[12:15], s64 offen offset:0 sc1 lds
    buffer_load_dwordx4 v5, s[12:15], s64 offen offset:1024 sc1 lds
    buffer_load_dwordx4 v5, s[12:15], s64 offen offset:2048 sc1 lds
    buffer_load_dwordx4 v5, s[12:15], s64 offen offset:3072 sc1 lds
    s_add_u32 s64, s85, 4096
    s_add_u32 m0, s86, 4096
    s_nop 0
    buffer_load_dwordx4 v5, s[12:15], s64 offen offset:0 sc1 lds
    s_add_u32 s64, s85, 20480
    s_add_u32 m0, s86, 5120
    s_nop 0
    buffer_load_dwordx4 v5, s[12:15], s64 offen offset:0 sc1 lds
    buffer_load_dwordx4 v5, s[12:15], s64 offen offset:1024 sc1 lds
    buffer_load_dwordx4 v5, s[12:15], s64 offen offset:2048 sc1 lds
    buffer_load_dwordx4 v5, s[12:15], s64 offen offset:3072 sc1 lds
    s_add_u32 s64, s85, 24576
    s_add_u32 m0, s86, 9216
    s_nop 0
    buffer_load_dwordx4 v5, s[12:15], s64 offen offset:0 sc1 lds
    s_add_u32 s64, s85, 40960
    s_add_u32 m0, s86, 10240
    s_nop 0
    buffer_load_dwordx4 v5, s[12:15], s64 offen offset:0 sc1 lds
    buffer_load_dwordx4 v5, s[12:15], s64 offen offset:1024 sc1 lds
    buffer_load_dwordx4 v5, s[12:15], s64 offen offset:2048 sc1 lds
    buffer_load_dwordx4 v5, s[12:15], s64 offen offset:3072 sc1 lds
    s_add_u32 s64, s85, 45056
    s_add_u32 m0, s86, 14336
    s_nop 0
    buffer_load_dwordx4 v5, s[12:15], s64 offen offset:0 sc1 lds
    s_add_u32 s64, s85, 61440
    s_add_u32 m0, s86, 15360
    s_nop 0
    buffer_load_dwordx4 v5, s[12:15], s64 offen offset:0 sc1 lds
    buffer_load_dwordx4 v5, s[12:15], s64 offen offset:1024 sc1 lds
    buffer_load_dwordx4 v5, s[12:15], s64 offen offset:2048 sc1 lds
    buffer_load_dwordx4 v5, s[12:15], s64 offen offset:3072 sc1 lds
    s_add_u32 s64, s85, 65536
    s_add_u32 m0, s86, 19456
    s_nop 0
    buffer_load_dwordx4 v5, s[12:15], s64 offen offset:0 sc1 lds
    s_add_u32 s64, s85, 81920
    s_add_u32 m0, s86, 20480
    s_nop 0
    buffer_load_dwordx4 v5, s[12:15], s64 offen offset:0 sc1 lds
    buffer_load_dwordx4 v5, s[12:15], s64 offen offset:1024 sc1 lds
    buffer_load_dwordx4 v5, s[12:15], s64 offen offset:2048 sc1 lds
    buffer_load_dwordx4 v5, s[12:15], s64 offen offset:3072 sc1 lds
    s_add_u32 s64, s85, 86016
    s_add_u32 m0, s86, 24576
    s_nop 0
    buffer_load_dwordx4 v5, s[12:15], s64 offen offset:0 sc1 lds
    s_waitcnt vmcnt(49)
    s_setprio 0
    v_mfma_f32_16x16x32_bf16 v[16:19], v[132:135], v[152:155], v[16:19]
    v_mfma_f32_16x16x32_bf16 v[20:23], v[132:135], v[156:159], v[20:23]
    v_mfma_f32_16x16x32_bf16 v[24:27], v[132:135], v[160:163], v[24:27]
    v_mfma_f32_16x16x32_bf16 v[28:31], v[132:135], v[164:167], v[28:31]
    v_mfma_f32_16x16x32_bf16 v[32:35], v[136:139], v[152:155], v[32:35]
    v_mfma_f32_16x16x32_bf16 v[36:39], v[136:139], v[156:159], v[36:39]
    v_mfma_f32_16x16x32_bf16 v[40:43], v[136:139], v[160:163], v[40:43]
    v_mfma_f32_16x16x32_bf16 v[44:47], v[136:139], v[164:167], v[44:47]
    v_mfma_f32_16x16x32_bf16 v[48:51], v[140:143], v[152:155], v[48:51]
    v_mfma_f32_16x16x32_bf16 v[52:55], v[140:143], v[156:159], v[52:55]
    v_mfma_f32_16x16x32_bf16 v[56:59], v[140:143], v[160:163], v[56:59]
    v_mfma_f32_16x16x32_bf16 v[60:63], v[140:143], v[164:167], v[60:63]
    v_mfma_f32_16x16x32_bf16 v[64:67], v[144:147], v[152:155], v[64:67]
    v_mfma_f32_16x16x32_bf16 v[68:71], v[144:147], v[156:159], v[68:71]
    v_mfma_f32_16x16x32_bf16 v[72:75], v[144:147], v[160:163], v[72:75]
    v_mfma_f32_16x16x32_bf16 v[76:79], v[144:147], v[164:167], v[76:79]
    v_mfma_f32_16x16x32_bf16 v[80:83], v[148:151], v[152:155], v[80:83]
    v_mfma_f32_16x16x32_bf16 v[84:87], v[148:151], v[156:159], v[84:87]
    v_mfma_f32_16x16x32_bf16 v[88:91], v[148:151], v[160:163], v[88:91]
    v_mfma_f32_16x16x32_bf16 v[92:95], v[148:151], v[164:167], v[92:95]
    s_setprio 3
    s_add_u32 s64, s92, 10240
    buffer_load_dwordx4 v[132:135], v5, s[12:15], s64 offen sc1
    s_add_u32 s64, s92, 59392
    buffer_load_dwordx4 v[136:139], v5, s[12:15], s64 offen sc1
    s_add_u32 s64, s92, 108544
    buffer_load_dwordx4 v[140:143], v5, s[12:15], s64 offen sc1
    s_add_u32 s64, s92, 157696
    buffer_load_dwordx4 v[144:147], v5, s[12:15], s64 offen sc1
    s_add_u32 s64, s92, 206848
    buffer_load_dwordx4 v[148:151], v5, s[12:15], s64 offen sc1
    s_add_u32 s64, s70, 10240
    buffer_load_dwordx4 v[152:155], v5, s[12:15], s64 offen sc1
    s_add_u32 s64, s71, 10240
    buffer_load_dwordx4 v[156:159], v5, s[12:15], s64 offen sc1
    s_add_u32 s64, s72, 10240
    buffer_load_dwordx4 v[160:163], v5, s[12:15], s64 offen sc1
    s_add_u32 s64, s73, 10240
    buffer_load_dwordx4 v[164:167], v5, s[12:15], s64 offen sc1
    s_barrier
    s_mov_b32 s84, 0
    v_and_b32 v14, 7, v0
    v_lshlrev_b32 v14, 7, v14
    s_lshr_b32 s60, s87, 6
    s_lshl_b32 s60, s60, 12
    s_lshl_b32 s61, s75, 10
    s_add_u32 s60, s60, s61
    s_add_u32 s65, s60, 19742720
    s_sub_u32 s60, s75, 1
    s_and_b32 s60, s60, 3
    s_mul_i32 s60, s60, 25600
    s_add_u32 s60, s60, 53504
    v_add_u32 v8, s60, v5
    s_sub_u32 s60, s75, 2
    s_and_b32 s60, s60, 3
    s_mul_i32 s60, s60, 25600
    s_add_u32 s60, s60, 58624
    v_add_u32 v9, s60, v5
    s_sub_u32 s60, s75, 3
    s_and_b32 s60, s60, 3
    s_mul_i32 s60, s60, 25600
    s_add_u32 s60, s60, 63744
    v_add_u32 v10, s60, v5
    s_mov_b32 s20, s46
    s_mov_b32 s21, s47
    s_mov_b32 s22, 2621440
    s_mov_b32 s23, 0x00020000
    v_and_b32 v13, 15, v0
    v_mul_u32_u24 v13, 1280, v13
    v_lshrrev_b32 v1, 4, v0
    v_lshl_add_u32 v13, v1, 4, v13
    s_lshl_b32 s60, s75, 4
    s_add_u32 s60, s60, s87
    s_mul_i32 s91, s60, 1280
    s_lshr_b32 s60, s88, 1
    s_lshl_b32 s60, s60, 6
    s_add_u32 s91, s91, s60
    v_mov_b32 v1, 53248
LH_bx:
    s_barrier
    ds_read_b32 v2, v1
    s_waitcnt lgkmcnt(0)
    v_readfirstlane_b32 s60, v2
    s_nop 1
    s_cmp_gt_u32 s60, s84
    s_cbranch_scc1 LH_replay
    s_waitcnt vmcnt(43)
    v_mfma_f32_16x16x32_bf16 v[16:19], v[168:171], v[188:191], v[16:19]
    v_mfma_f32_16x16x32_bf16 v[20:23], v[168:171], v[192:195], v[20:23]
    v_mfma_f32_16x16x32_bf16 v[24:27], v[168:171], v[196:199], v[24:27]
    v_mfma_f32_16x16x32_bf16 v[28:31], v[168:171], v[200:203], v[28:31]
    v_mfma_f32_16x16x32_bf16 v[32:35], v[172:175], v[188:191], v[32:35]
    v_mfma_f32_16x16x32_bf16 v[36:39], v[172:175], v[192:195], v[36:39]
    v_mfma_f32_16x16x32_bf16 v[40:43], v[172:175], v[196:199], v[40:43]
    v_mfma_f32_16x16x32_bf16 v[44:47], v[172:175], v[200:203], v[44:47]
    v_mfma_f32_16x16x32_bf16 v[48:51], v[176:179], v[188:191], v[48:51]
    v_mfma_f32_16x16x32_bf16 v[52:55], v[176:179], v[192:195], v[52:55]
    v_mfma_f32_16x16x32_bf16 v[56:59], v[176:179], v[196:199], v[56:59]
    v_mfma_f32_16x16x32_bf16 v[60:63], v[176:179], v[200:203], v[60:63]
    v_mfma_f32_16x16x32_bf16 v[64:67], v[180:183], v[188:191], v[64:67]
    v_mfma_f32_16x16x32_bf16 v[68:71], v[180:183], v[192:195], v[68:71]
    v_mfma_f32_16x16x32_bf16 v[72:75], v[180:183], v[196:199], v[72:75]
    v_mfma_f32_16x16x32_bf16 v[76:79], v[180:183], v[200:203], v[76:79]
    v_mfma_f32_16x16x32_bf16 v[80:83], v[184:187], v[188:191], v[80:83]
    v_mfma_f32_16x16x32_bf16 v[84:87], v[184:187], v[192:195], v[84:87]
    v_mfma_f32_16x16x32_bf16 v[88:91], v[184:187], v[196:199], v[88:91]
    v_mfma_f32_16x16x32_bf16 v[92:95], v[184:187], v[200:203], v[92:95]
    s_add_u32 s64, s92, 11264
    buffer_load_dwordx4 v[168:171], v5, s[12:15], s64 offen sc1
    s_add_u32 s64, s92, 60416
    buffer_load_dwordx4 v[172:175], v5, s[12:15], s64 offen sc1
    s_add_u32 s64, s92, 109568
    buffer_load_dwordx4 v[176:179], v5, s[12:15], s64 offen sc1
    s_add_u32 s64, s92, 158720
    buffer_load_dwordx4 v[180:183], v5, s[12:15], s64 offen sc1
    s_add_u32 s64, s92, 207872
    buffer_load_dwordx4 v[184:187], v5, s[12:15], s64 offen sc1
    s_add_u32 s64, s70, 11264
    buffer_load_dwordx4 v[188:191], v5, s[12:15], s64 offen sc1
    s_add_u32 s64, s71, 11264
    buffer_load_dwordx4 v[192:195], v5, s[12:15], s64 offen sc1
    s_add_u32 s64, s72, 11264
    buffer_load_dwordx4 v[196:199], v5, s[12:15], s64 offen sc1
    s_add_u32 s64, s73, 11264
    buffer_load_dwordx4 v[200:203], v5, s[12:15], s64 offen sc1
    s_waitcnt vmcnt(43)
    v_mfma_f32_16x16x32_bf16 v[16:19], v[96:99], v[116:119], v[16:19]
    v_mfma_f32_16x16x32_bf16 v[20:23], v[96:99], v[120:123], v[20:23]
    v_mfma_f32_16x16x32_bf16 v[24:27], v[96:99], v[124:127], v[24:27]
    v_mfma_f32_16x16x32_bf16 v[28:31], v[96:99], v[128:131], v[28:31]
    v_mfma_f32_16x16x32_bf16 v[32:35], v[100:103], v[116:119], v[32:35]
    v_mfma_f32_16x16x32_bf16 v[36:39], v[100:103], v[120:123], v[36:39]
    v_mfma_f32_16x16x32_bf16 v[40:43], v[100:103], v[124:127], v[40:43]
    v_mfma_f32_16x16x32_bf16 v[44:47], v[100:103], v[128:131], v[44:47]
    v_mfma_f32_16x16x32_bf16 v[48:51], v[104:107], v[116:119], v[48:51]
    v_mfma_f32_16x16x32_bf16 v[52:55], v[104:107], v[120:123], v[52:55]
    v_mfma_f32_16x16x32_bf16 v[56:59], v[104:107], v[124:127], v[56:59]
    v_mfma_f32_16x16x32_bf16 v[60:63], v[104:107], v[128:131], v[60:63]
    v_mfma_f32_16x16x32_bf16 v[64:67], v[108:111], v[116:119], v[64:67]
    v_mfma_f32_16x16x32_bf16 v[68:71], v[108:111], v[120:123], v[68:71]
    v_mfma_f32_16x16x32_bf16 v[72:75], v[108:111], v[124:127], v[72:75]
    v_mfma_f32_16x16x32_bf16 v[76:79], v[108:111], v[128:131], v[76:79]
    v_mfma_f32_16x16x32_bf16 v[80:83], v[112:115], v[116:119], v[80:83]
    v_mfma_f32_16x16x32_bf16 v[84:87], v[112:115], v[120:123], v[84:87]
    v_mfma_f32_16x16x32_bf16 v[88:91], v[112:115], v[124:127], v[88:91]
    v_mfma_f32_16x16x32_bf16 v[92:95], v[112:115], v[128:131], v[92:95]
    s_waitcnt vmcnt(9)
    v_mfma_f32_16x16x32_bf16 v[16:19], v[132:135], v[152:155], v[16:19]
    v_mfma_f32_16x16x32_bf16 v[20:23], v[132:135], v[156:159], v[20:23]
    v_mfma_f32_16x16x32_bf16 v[24:27], v[132:135], v[160:163], v[24:27]
    v_mfma_f32_16x16x32_bf16 v[28:31], v[132:135], v[164:167], v[28:31]
    v_mfma_f32_16x16x32_bf16 v[32:35], v[136:139], v[152:155], v[32:35]
    v_mfma_f32_16x16x32_bf16 v[36:39], v[136:139], v[156:159], v[36:39]
    v_mfma_f32_16x16x32_bf16 v[40:43], v[136:139], v[160:163], v[40:43]
    v_mfma_f32_16x16x32_bf16 v[44:47], v[136:139], v[164:167], v[44:47]
    v_mfma_f32_16x16x32_bf16 v[48:51], v[140:143], v[152:155], v[48:51]
    v_mfma_f32_16x16x32_bf16 v[52:55], v[140:143], v[156:159], v[52:55]
    v_mfma_f32_16x16x32_bf16 v[56:59], v[140:143], v[160:163], v[56:59]
    v_mfma_f32_16x16x32_bf16 v[60:63], v[140:143], v[164:167], v[60:63]
    v_mfma_f32_16x16x32_bf16 v[64:67], v[144:147], v[152:155], v[64:67]
    v_mfma_f32_16x16x32_bf16 v[68:71], v[144:147], v[156:159], v[68:71]
    v_mfma_f32_16x16x32_bf16 v[72:75], v[144:147], v[160:163], v[72:75]
    v_mfma_f32_16x16x32_bf16 v[76:79], v[144:147], v[164:167], v[76:79]
    v_mfma_f32_16x16x32_bf16 v[80:83], v[148:151], v[152:155], v[80:83]
    v_mfma_f32_16x16x32_bf16 v[84:87], v[148:151], v[156:159], v[84:87]
    v_mfma_f32_16x16x32_bf16 v[88:91], v[148:151], v[160:163], v[88:91]
    v_mfma_f32_16x16x32_bf16 v[92:95], v[148:151], v[164:167], v[92:95]
    s_waitcnt vmcnt(0)
    v_mfma_f32_16x16x32_bf16 v[16:19], v[168:171], v[188:191], v[16:19]
    v_mfma_f32_16x16x32_bf16 v[20:23], v[168:171], v[192:195], v[20:23]
    v_mfma_f32_16x16x32_bf16 v[24:27], v[168:171], v[196:199], v[24:27]
    v_mfma_f32_16x16x32_bf16 v[28:31], v[168:171], v[200:203], v[28:31]
    v_mfma_f32_16x16x32_bf16 v[32:35], v[172:175], v[188:191], v[32:35]
    v_mfma_f32_16x16x32_bf16 v[36:39], v[172:175], v[192:195], v[36:39]
    v_mfma_f32_16x16x32_bf16 v[40:43], v[172:175], v[196:199], v[40:43]
    v_mfma_f32_16x16x32_bf16 v[44:47], v[172:175], v[200:203], v[44:47]
    v_mfma_f32_16x16x32_bf16 v[48:51], v[176:179], v[188:191], v[48:51]
    v_mfma_f32_16x16x32_bf16 v[52:55], v[176:179], v[192:195], v[52:55]
    v_mfma_f32_16x16x32_bf16 v[56:59], v[176:179], v[196:199], v[56:59]
    v_mfma_f32_16x16x32_bf16 v[60:63], v[176:179], v[200:203], v[60:63]
    v_mfma_f32_16x16x32_bf16 v[64:67], v[180:183], v[188:191], v[64:67]
    v_mfma_f32_16x16x32_bf16 v[68:71], v[180:183], v[192:195], v[68:71]
    v_mfma_f32_16x16x32_bf16 v[72:75], v[180:183], v[196:199], v[72:75]
    v_mfma_f32_16x16x32_bf16 v[76:79], v[180:183], v[200:203], v[76:79]
    v_mfma_f32_16x16x32_bf16 v[80:83], v[184:187], v[188:191], v[80:83]
    v_mfma_f32_16x16x32_bf16 v[84:87], v[184:187], v[192:195], v[84:87]
    v_mfma_f32_16x16x32_bf16 v[88:91], v[184:187], v[196:199], v[88:91]
    v_mfma_f32_16x16x32_bf16 v[92:95], v[184:187], v[200:203], v[92:95]
    s_mul_i32 s61, s75, 5120
    s_lshr_b32 s60, s87, 4
    s_add_u32 s62, s75, 0
    s_and_b32 s62, s62, 3
    s_add_u32 s62, s62, s60
    s_mul_i32 s62, s62, 20480
    s_add_u32 s62, s62, s61
    s_add_u32 s70, s62, 16941056
    s_add_u32 s62, s75, 1
    s_and_b32 s62, s62, 3
    s_add_u32 s62, s62, s60
    s_mul_i32 s62, s62, 20480
    s_add_u32 s62, s62, s61
    s_add_u32 s71, s62, 16941056
    s_add_u32 s62, s75, 2
    s_and_b32 s62, s62, 3
    s_add_u32 s62, s62, s60
    s_mul_i32 s62, s62, 20480
    s_add_u32 s62, s62, s61
    s_add_u32 s72, s62, 16941056
    s_add_u32 s62, s75, 3
    s_and_b32 s62, s62, 3
    s_add_u32 s62, s62, s60
    s_mul_i32 s62, s62, 20480
    s_add_u32 s62, s62, s61
    s_add_u32 s73, s62, 16941056
    s_mov_b32 s58, 0x20000
LH_s3:
    buffer_load_dwordx2 v[6:7], v14, s[12:15], s65 offen sc1
    s_waitcnt vmcnt(0)
    v_cmp_eq_u32 vcc, s76, v6
    v_cmp_eq_u32 s[62:63], s77, v7
    s_nop 0
    s_and_b64 vcc, vcc, s[62:63]
    s_cmp_eq_u64 vcc, exec
    s_cbranch_scc1 LH_s3_ok
    s_sleep 1
    s_sub_u32 s58, s58, 1
    s_cmp_lg_u32 s58, 0
    s_cbranch_scc1 LH_s3
LH_s3_ok:
    buffer_load_dwordx4 v[176:179], v5, s[12:15], s70 offen offset:0 sc1
    buffer_load_dwordx4 v[180:183], v5, s[12:15], s71 offen offset:0 sc1
    buffer_load_dwordx4 v[184:187], v5, s[12:15], s72 offen offset:0 sc1
    buffer_load_dwordx4 v[188:191], v5, s[12:15], s73 offen offset:0 sc1
    buffer_load_dwordx4 v[192:195], v5, s[12:15], s70 offen offset:1024 sc1
    buffer_load_dwordx4 v[196:199], v5, s[12:15], s71 offen offset:1024 sc1
    buffer_load_dwordx4 v[200:203], v5, s[12:15], s72 offen offset:1024 sc1
    buffer_load_dwordx4 v[204:207], v5, s[12:15], s73 offen offset:1024 sc1
    buffer_load_dwordx4 v[208:211], v5, s[12:15], s70 offen offset:2048 sc1
    buffer_load_dwordx4 v[212:215], v5, s[12:15], s71 offen offset:2048 sc1
    buffer_load_dwordx4 v[216:219], v5, s[12:15], s72 offen offset:2048 sc1
    buffer_load_dwordx4 v[220:223], v5, s[12:15], s73 offen offset:2048 sc1
    buffer_load_dwordx4 v[224:227], v5, s[12:15], s70 offen offset:3072 sc1
    buffer_load_dwordx4 v[228:231], v5, s[12:15], s71 offen offset:3072 sc1
    buffer_load_dwordx4 v[232:235], v5, s[12:15], s72 offen offset:3072 sc1
    buffer_load_dwordx4 v[236:239], v5, s[12:15], s73 offen offset:3072 sc1
    s_add_u32 s64, s70, 4096
    buffer_load_dwordx4 v[240:243], v5, s[12:15], s64 offen sc1
    s_add_u32 s64, s71, 4096
    buffer_load_dwordx4 v[244:247], v5, s[12:15], s64 offen sc1
    s_add_u32 s64, s72, 4096
    buffer_load_dwordx4 v[248:251], v5, s[12:15], s64 offen sc1
    s_add_u32 s64, s73, 4096
    buffer_load_dwordx4 v[252:255], v5, s[12:15], s64 offen sc1
    ds_read_b128 v[96:99], v12 offset:0
    ds_read_b128 v[100:103], v12 offset:5120
    ds_read_b128 v[104:107], v12 offset:10240
    ds_read_b128 v[108:111], v12 offset:15360
    ds_read_b128 v[112:115], v12 offset:20480
    ds_read_b128 v[116:119], v12 offset:1024
    ds_read_b128 v[120:123], v12 offset:6144
    ds_read_b128 v[124:127], v12 offset:11264
    ds_read_b128 v[128:131], v12 offset:16384
    ds_read_b128 v[132:135], v12 offset:21504
    ds_read_b128 v[136:139], v12 offset:2048
    ds_read_b128 v[140:143], v12 offset:7168
    ds_read_b128 v[144:147], v12 offset:12288
    ds_read_b128 v[148:151], v12 offset:17408
    ds_read_b128 v[152:155], v12 offset:22528
    s_waitcnt vmcnt(16) lgkmcnt(10)
    v_mfma_f32_16x16x32_bf16 v[16:19], v[96:99], v[176:179], v[16:19]
    v_mfma_f32_16x16x32_bf16 v[20:23], v[96:99], v[180:183], v[20:23]
    v_mfma_f32_16x16x32_bf16 v[24:27], v[96:99], v[184:187], v[24:27]
    v_mfma_f32_16x16x32_bf16 v[28:31], v[96:99], v[188:191], v[28:31]
    v_mfma_f32_16x16x32_bf16 v[32:35], v[100:103], v[176:179], v[32:35]
    v_mfma_f32_16x16x32_bf16 v[36:39], v[100:103], v[180:183], v[36:39]
    v_mfma_f32_16x16x32_bf16 v[40:43], v[100:103], v[184:187], v[40:43]
    v_mfma_f32_16x16x32_bf16 v[44:47], v[100:103], v[188:191], v[44:47]
    v_mfma_f32_16x16x32_bf16 v[48:51], v[104:107], v[176:179], v[48:51]
    v_mfma_f32_16x16x32_bf16 v[52:55], v[104:107], v[180:183], v[52:55]
    v_mfma_f32_16x16x32_bf16 v[56:59], v[104:107], v[184:187], v[56:59]
    v_mfma_f32_16x16x32_bf16 v[60:63], v[104:107], v[188:191], v[60:63]
    v_mfma_f32_16x16x32_bf16 v[64:67], v[108:111], v[176:179], v[64:67]
    v_mfma_f32_16x16x32_bf16 v[68:71], v[108:111], v[180:183], v[68:71]
    v_mfma_f32_16x16x32_bf16 v[72:75], v[108:111], v[184:187], v[72:75]
    v_mfma_f32_16x16x32_bf16 v[76:79], v[108:111], v[188:191], v[76:79]
    v_mfma_f32_16x16x32_bf16 v[80:83], v[112:115], v[176:179], v[80:83]
    v_mfma_f32_16x16x32_bf16 v[84:87], v[112:115], v[180:183], v[84:87]
    v_mfma_f32_16x16x32_bf16 v[88:91], v[112:115], v[184:187], v[88:91]
    v_mfma_f32_16x16x32_bf16 v[92:95], v[112:115], v[188:191], v[92:95]
    ds_read_b128 v[96:99], v12 offset:3072
    ds_read_b128 v[100:103], v12 offset:8192
    ds_read_b128 v[104:107], v12 offset:13312
    ds_read_b128 v[108:111], v12 offset:18432
    ds_read_b128 v[112:115], v12 offset:23552
    s_waitcnt vmcnt(12) lgkmcnt(10)
    v_mfma_f32_16x16x32_bf16 v[16:19], v[116:119], v[192:195], v[16:19]
    v_mfma_f32_16x16x32_bf16 v[20:23], v[116:119], v[196:199], v[20:23]
    v_mfma_f32_16x16x32_bf16 v[24:27], v[116:119], v[200:203], v[24:27]
    v_mfma_f32_16x16x32_bf16 v[28:31], v[116:119], v[204:207], v[28:31]
    v_mfma_f32_16x16x32_bf16 v[32:35], v[120:123], v[192:195], v[32:35]
    v_mfma_f32_16x16x32_bf16 v[36:39], v[120:123], v[196:199], v[36:39]
    v_mfma_f32_16x16x32_bf16 v[40:43], v[120:123], v[200:203], v[40:43]
    v_mfma_f32_16x16x32_bf16 v[44:47], v[120:123], v[204:207], v[44:47]
    v_mfma_f32_16x16x32_bf16 v[48:51], v[124:127], v[192:195], v[48:51]
    v_mfma_f32_16x16x32_bf16 v[52:55], v[124:127], v[196:199], v[52:55]
    v_mfma_f32_16x16x32_bf16 v[56:59], v[124:127], v[200:203], v[56:59]
    v_mfma_f32_16x16x32_bf16 v[60:63], v[124:127], v[204:207], v[60:63]
    v_mfma_f32_16x16x32_bf16 v[64:67], v[128:131], v[192:195], v[64:67]
    v_mfma_f32_16x16x32_bf16 v[68:71], v[128:131], v[196:199], v[68:71]
    v_mfma_f32_16x16x32_bf16 v[72:75], v[128:131], v[200:203], v[72:75]
    v_mfma_f32_16x16x32_bf16 v[76:79], v[128:131], v[204:207], v[76:79]
    v_mfma_f32_16x16x32_bf16 v[80:83], v[132:135], v[192:195], v[80:83]
    v_mfma_f32_16x16x32_bf16 v[84:87], v[132:135], v[196:199], v[84:87]
    v_mfma_f32_16x16x32_bf16 v[88:91], v[132:135], v[200:203], v[88:91]
    v_mfma_f32_16x16x32_bf16 v[92:95], v[132:135], v[204:207], v[92:95]
    ds_read_b128 v[116:119], v12 offset:4096
    ds_read_b128 v[120:123], v12 offset:9216
    ds_read_b128 v[124:127], v12 offset:14336
    ds_read_b128 v[128:131], v12 offset:19456
    ds_read_b128 v[132:135], v12 offset:24576
    s_waitcnt vmcnt(8) lgkmcnt(10)
    v_mfma_f32_16x16x32_bf16 v[16:19], v[136:139], v[208:211], v[16:19]
    v_mfma_f32_16x16x32_bf16 v[20:23], v[136:139], v[212:215], v[20:23]
    v_mfma_f32_16x16x32_bf16 v[24:27], v[136:139], v[216:219], v[24:27]
    v_mfma_f32_16x16x32_bf16 v[28:31], v[136:139], v[220:223], v[28:31]
    v_mfma_f32_16x16x32_bf16 v[32:35], v[140:143], v[208:211], v[32:35]
    v_mfma_f32_16x16x32_bf16 v[36:39], v[140:143], v[212:215], v[36:39]
    v_mfma_f32_16x16x32_bf16 v[40:43], v[140:143], v[216:219], v[40:43]
    v_mfma_f32_16x16x32_bf16 v[44:47], v[140:143], v[220:223], v[44:47]
    v_mfma_f32_16x16x32_bf16 v[48:51], v[144:147], v[208:211], v[48:51]
    v_mfma_f32_16x16x32_bf16 v[52:55], v[144:147], v[212:215], v[52:55]
    v_mfma_f32_16x16x32_bf16 v[56:59], v[144:147], v[216:219], v[56:59]
    v_mfma_f32_16x16x32_bf16 v[60:63], v[144:147], v[220:223], v[60:63]
    v_mfma_f32_16x16x32_bf16 v[64:67], v[148:151], v[208:211], v[64:67]
    v_mfma_f32_16x16x32_bf16 v[68:71], v[148:151], v[212:215], v[68:71]
    v_mfma_f32_16x16x32_bf16 v[72:75], v[148:151], v[216:219], v[72:75]
    v_mfma_f32_16x16x32_bf16 v[76:79], v[148:151], v[220:223], v[76:79]
    v_mfma_f32_16x16x32_bf16 v[80:83], v[152:155], v[208:211], v[80:83]
    v_mfma_f32_16x16x32_bf16 v[84:87], v[152:155], v[212:215], v[84:87]
    v_mfma_f32_16x16x32_bf16 v[88:91], v[152:155], v[216:219], v[88:91]
    v_mfma_f32_16x16x32_bf16 v[92:95], v[152:155], v[220:223], v[92:95]
    s_waitcnt vmcnt(4) lgkmcnt(5)
    v_mfma_f32_16x16x32_bf16 v[16:19], v[96:99], v[224:227], v[16:19]
    v_mfma_f32_16x16x32_bf16 v[20:23], v[96:99], v[228:231], v[20:23]
    v_mfma_f32_16x16x32_bf16 v[24:27], v[96:99], v[232:235], v[24:27]
    v_mfma_f32_16x16x32_bf16 v[28:31], v[96:99], v[236:239], v[28:31]
    v_mfma_f32_16x16x32_bf16 v[32:35], v[100:103], v[224:227], v[32:35]
    v_mfma_f32_16x16x32_bf16 v[36:39], v[100:103], v[228:231], v[36:39]
    v_mfma_f32_16x16x32_bf16 v[40:43], v[100:103], v[232:235], v[40:43]
    v_mfma_f32_16x16x32_bf16 v[44:47], v[100:103], v[236:239], v[44:47]
    v_mfma_f32_16x16x32_bf16 v[48:51], v[104:107], v[224:227], v[48:51]
    v_mfma_f32_16x16x32_bf16 v[52:55], v[104:107], v[228:231], v[52:55]
    v_mfma_f32_16x16x32_bf16 v[56:59], v[104:107], v[232:235], v[56:59]
    v_mfma_f32_16x16x32_bf16 v[60:63], v[104:107], v[236:239], v[60:63]
    v_mfma_f32_16x16x32_bf16 v[64:67], v[108:111], v[224:227], v[64:67]
    v_mfma_f32_16x16x32_bf16 v[68:71], v[108:111], v[228:231], v[68:71]
    v_mfma_f32_16x16x32_bf16 v[72:75], v[108:111], v[232:235], v[72:75]
    v_mfma_f32_16x16x32_bf16 v[76:79], v[108:111], v[236:239], v[76:79]
    v_mfma_f32_16x16x32_bf16 v[80:83], v[112:115], v[224:227], v[80:83]
    v_mfma_f32_16x16x32_bf16 v[84:87], v[112:115], v[228:231], v[84:87]
    v_mfma_f32_16x16x32_bf16 v[88:91], v[112:115], v[232:235], v[88:91]
    v_mfma_f32_16x16x32_bf16 v[92:95], v[112:115], v[236:239], v[92:95]
    s_waitcnt vmcnt(0) lgkmcnt(0)
    v_mfma_f32_16x16x32_bf16 v[20:23], v[116:119], v[244:247], v[20:23]
    v_mfma_f32_16x16x32_bf16 v[36:39], v[120:123], v[244:247], v[36:39]
    v_mfma_f32_16x16x32_bf16 v[52:55], v[124:127], v[244:247], v[52:55]
    v_mfma_f32_16x16x32_bf16 v[68:71], v[128:131], v[244:247], v[68:71]
    v_mfma_f32_16x16x32_bf16 v[84:87], v[132:135], v[244:247], v[84:87]
    v_mfma_f32_16x16x32_bf16 v[24:27], v[116:119], v[248:251], v[24:27]
    v_mfma_f32_16x16x32_bf16 v[40:43], v[120:123], v[248:251], v[40:43]
    v_mfma_f32_16x16x32_bf16 v[56:59], v[124:127], v[248:251], v[56:59]
    v_mfma_f32_16x16x32_bf16 v[72:75], v[128:131], v[248:251], v[72:75]
    v_mfma_f32_16x16x32_bf16 v[88:91], v[132:135], v[248:251], v[88:91]
    v_mfma_f32_16x16x32_bf16 v[28:31], v[116:119], v[252:255], v[28:31]
    v_mfma_f32_16x16x32_bf16 v[44:47], v[120:123], v[252:255], v[44:47]
    v_mfma_f32_16x16x32_bf16 v[60:63], v[124:127], v[252:255], v[60:63]
    v_mfma_f32_16x16x32_bf16 v[76:79], v[128:131], v[252:255], v[76:79]
    v_mfma_f32_16x16x32_bf16 v[92:95], v[132:135], v[252:255], v[92:95]
    v_mfma_f32_16x16x32_bf16 v[16:19], v[116:119], v[240:243], v[16:19]
    v_mfma_f32_16x16x32_bf16 v[32:35], v[120:123], v[240:243], v[32:35]
    v_mfma_f32_16x16x32_bf16 v[48:51], v[124:127], v[240:243], v[48:51]
    v_mfma_f32_16x16x32_bf16 v[64:67], v[128:131], v[240:243], v[64:67]
    v_mfma_f32_16x16x32_bf16 v[80:83], v[132:135], v[240:243], v[80:83]
    ds_write_b128 v12, v[20:23] offset:0
    ds_write_b128 v12, v[36:39] offset:1024
    ds_write_b128 v12, v[52:55] offset:2048
    ds_write_b128 v12, v[68:71] offset:3072
    ds_write_b128 v12, v[84:87] offset:4096
    ds_write_b128 v12, v[24:27] offset:5120
    ds_write_b128 v12, v[40:43] offset:6144
    ds_write_b128 v12, v[56:59] offset:7168
    ds_write_b128 v12, v[72:75] offset:8192
    ds_write_b128 v12, v[88:91] offset:9216
    s_nop 1
    ds_write_b128 v12, v[28:31] offset:10240
    ds_write_b128 v12, v[44:47] offset:11264
    ds_write_b128 v12, v[60:63] offset:12288
    ds_write_b128 v12, v[76:79] offset:13312
    ds_write_b128 v12, v[92:95] offset:14336
    s_waitcnt lgkmcnt(0)
    s_barrier
    ds_read_b128 v[116:119], v8 offset:0
    ds_read_b128 v[120:123], v8 offset:1024
    ds_read_b128 v[124:127], v8 offset:2048
    ds_read_b128 v[128:131], v8 offset:3072
    ds_read_b128 v[132:135], v8 offset:4096
    ds_read_b128 v[136:139], v9 offset:0
    ds_read_b128 v[140:143], v9 offset:1024
    ds_read_b128 v[144:147], v9 offset:2048
    ds_read_b128 v[148:151], v9 offset:3072
    ds_read_b128 v[152:155], v9 offset:4096
    ds_read_b128 v[156:159], v10 offset:0
    ds_read_b128 v[160:163], v10 offset:1024
    ds_read_b128 v[164:167], v10 offset:2048
    ds_read_b128 v[168:171], v10 offset:3072
    ds_read_b128 v[172:175], v10 offset:4096
    v_mov_b32 v5, v4
    s_waitcnt lgkmcnt(10)
    v_pk_add_f32 v[16:17], v[16:17], v[116:117]
    v_pk_add_f32 v[18:19], v[18:19], v[118:119]
    v_pk_add_f32 v[32:33], v[32:33], v[120:121]
    v_pk_add_f32 v[34:35], v[34:35], v[122:123]
    v_pk_add_f32 v[48:49], v[48:49], v[124:125]
    v_pk_add_f32 v[50:51], v[50:51], v[126:127]
    v_pk_add_f32 v[64:65], v[64:65], v[128:129]
    v_pk_add_f32 v[66:67], v[66:67], v[130:131]
    v_pk_add_f32 v[80:81], v[80:81], v[132:133]
    v_pk_add_f32 v[82:83], v[82:83], v[134:135]
    s_waitcnt lgkmcnt(5)
    v_pk_add_f32 v[16:17], v[16:17], v[136:137]
    v_pk_add_f32 v[18:19], v[18:19], v[138:139]
    v_pk_add_f32 v[32:33], v[32:33], v[140:141]
    v_pk_add_f32 v[34:35], v[34:35], v[142:143]
    v_pk_add_f32 v[48:49], v[48:49], v[144:145]
    v_pk_add_f32 v[50:51], v[50:51], v[146:147]
    v_pk_add_f32 v[64:65], v[64:65], v[148:149]
    v_pk_add_f32 v[66:67], v[66:67], v[150:151]
    v_pk_add_f32 v[80:81], v[80:81], v[152:153]
    v_pk_add_f32 v[82:83], v[82:83], v[154:155]
    s_waitcnt lgkmcnt(0)
    v_pk_add_f32 v[16:17], v[16:17], v[156:157]
    v_pk_add_f32 v[18:19], v[18:19], v[158:159]
    v_pk_add_f32 v[32:33], v[32:33], v[160:161]
    v_pk_add_f32 v[34:35], v[34:35], v[162:163]
    v_pk_add_f32 v[48:49], v[48:49], v[164:165]
    v_pk_add_f32 v[50:51], v[50:51], v[166:167]
    v_pk_add_f32 v[64:65], v[64:65], v[168:169]
    v_pk_add_f32 v[66:67], v[66:67], v[170:171]
    v_pk_add_f32 v[80:81], v[80:81], v[172:173]
    v_pk_add_f32 v[82:83], v[82:83], v[174:175]
    v_pk_mul_f32 v[16:17], v[16:17], v[4:5]
    v_pk_mul_f32 v[18:19], v[18:19], v[4:5]
    v_pk_mul_f32 v[32:33], v[32:33], v[4:5]
    v_pk_mul_f32 v[34:35], v[34:35], v[4:5]
    v_pk_mul_f32 v[48:49], v[48:49], v[4:5]
    v_pk_mul_f32 v[50:51], v[50:51], v[4:5]
    v_pk_mul_f32 v[64:65], v[64:65], v[4:5]
    v_pk_mul_f32 v[66:67], v[66:67], v[4:5]
    v_pk_mul_f32 v[80:81], v[80:81], v[4:5]
    v_pk_mul_f32 v[82:83], v[82:83], v[4:5]
    v_cvt_pk_bf16_f32 v180, v16, v17
    v_cvt_pk_bf16_f32 v181, v18, v19
    v_cvt_pk_bf16_f32 v182, v32, v33
    v_cvt_pk_bf16_f32 v183, v34, v35
    v_cvt_pk_bf16_f32 v184, v48, v49
    v_cvt_pk_bf16_f32 v185, v50, v51
    v_cvt_pk_bf16_f32 v186, v64, v65
    v_cvt_pk_bf16_f32 v187, v66, v67
    v_cvt_pk_bf16_f32 v188, v80, v81
    v_cvt_pk_bf16_f32 v189, v82, v83
    s_bitcmp1_b32 s88, 0
    s_cbranch_scc1 LH_odd
    buffer_store_dwordx4 v[180:183], v13, s[20:23], s91 offen
    buffer_store_dwordx4 v[184:187], v13, s[20:23], s91 offen offset:64
    buffer_store_dwordx2 v[188:189], v13, s[20:23], s91 offen offset:128
    s_branch LH_fin
LH_odd:
    buffer_store_dwordx2 v[180:181], v13, s[20:23], s91 offen offset:8
    buffer_store_dwordx4 v[182:185], v13, s[20:23], s91 offen offset:64
    buffer_store_dwordx4 v[186:189], v13, s[20:23], s91 offen offset:128
LH_fin:
    s_endpgm
LH_replay:
    s_waitcnt vmcnt(0)
    s_mov_b32 s84, 1
    s_mov_b32 s82, s89
    s_mov_b32 s83, s90
    s_mov_b32 s58, 8
LH_rloop:
    s_bitcmp1_b32 s75, 1
    s_cbranch_scc1 LH_dr_v
    s_add_u32 m0, s83, 0
    s_add_u32 s64, s82, 0
    buffer_load_dwordx4 v5, s[12:15], s64 offen offset:0 sc1 lds
    buffer_load_dwordx4 v5, s[12:15], s64 offen offset:1024 sc1 lds
    s_add_u32 m0, s83, 2048
    s_add_u32 s64, s82, 16384
    buffer_load_dwordx4 v5, s[12:15], s64 offen offset:0 sc1 lds
    buffer_load_dwordx4 v5, s[12:15], s64 offen offset:1024 sc1 lds
    s_add_u32 m0, s83, 4096
    s_add_u32 s64, s82, 32768
    buffer_load_dwordx4 v5, s[12:15], s64 offen offset:0 sc1 lds
    buffer_load_dwordx4 v5, s[12:15], s64 offen offset:1024 sc1 lds
    s_branch LH_dr_e
LH_dr_v:
    s_mov_b32 exec_lo, 0x000fffff
    s_mov_b32 exec_hi, 0x000fffff
    s_add_u32 m0, s83, 0
    s_add_u32 s64, s82, 0
    buffer_load_dwordx4 v3, s[12:15], s64 offen sc1 lds
    s_add_u32 m0, s83, 1024
    s_add_u32 s64, s82, 640
    buffer_load_dwordx4 v3, s[12:15], s64 offen sc1 lds
    s_add_u32 m0, s83, 2048
    s_add_u32 s64, s82, 1280
    buffer_load_dwordx4 v3, s[12:15], s64 offen sc1 lds
    s_add_u32 m0, s83, 3072
    s_add_u32 s64, s82, 1920
    buffer_load_dwordx4 v3, s[12:15], s64 offen sc1 lds
    s_add_u32 m0, s83, 4096
    s_add_u32 s64, s82, 2560
    buffer_load_dwordx4 v3, s[12:15], s64 offen sc1 lds
    s_add_u32 m0, s83, 5120
    s_add_u32 s64, s82, 3200
    buffer_load_dwordx4 v3, s[12:15], s64 offen sc1 lds
    s_add_u32 m0, s83, 6144
    s_add_u32 s64, s82, 3840
    buffer_load_dwordx4 v3, s[12:15], s64 offen sc1 lds
    s_add_u32 m0, s83, 7168
    s_add_u32 s64, s82, 4480
    buffer_load_dwordx4 v3, s[12:15], s64 offen sc1 lds
    s_mov_b64 exec, -1
LH_dr_e:
    s_waitcnt vmcnt(0)
    s_barrier
    s_bitcmp1_b32 s75, 1
    s_cselect_b32 s60, 10, 2
    s_lshl_b32 s60, s60, 10
    s_add_u32 s82, s82, s60
    s_bitcmp1_b32 s58, 0
    s_cselect_b32 s60, 0, 26624
    s_add_u32 s83, s90, s60
    s_sub_u32 s58, s58, 1
    s_cmp_lg_u32 s58, 0
    s_cbranch_scc1 LH_rloop
    s_barrier
    s_branch LH_bx
L_A:
    s_getpc_b64 s[80:81]
LPC:
    s_sub_u32 s80, s80, LPC-gated_mix__softmax_full_mha__dense_activation_squared_relu__prompt_kernel
    s_subb_u32 s81, s81, 0
    v_lshlrev_b32 v8, 4, v0
    s_lshl_b32 s60, s52, 10
    v_add_u32 v1, s60, v8
    v_lshrrev_b32 v11, 4, v0
    v_and_b32 v10, 15, v0
    s_lshr_b32 s61, s2, 3
    s_mul_i32 s61, s61, ((L_end-gated_mix__softmax_full_mha__dense_activation_squared_relu__prompt_kernel-2048)/124)*4
    v_lshlrev_b32 v1, 2, v0
    s_lshl_b32 s60, s52, 8
    s_add_u32 s61, s61, s60
    v_add_u32 v1, s61, v1
    global_load_dword v24, v1, s[80:81]
    global_load_dword v25, v1, s[80:81] offset:1024
    s_lshr_b32 s60, s52, 1
    s_and_b32 s61, s52, 1
    v_and_b32 v12, 7, v0
    v_xor_b32 v12, v11, v12
    v_lshlrev_b32 v12, 4, v12
    v_lshl_add_u32 v2, v10, 7, v12
    s_lshl_b32 s62, s60, 13
    v_add_u32 v2, s62, v2
    v_xor_b32 v3, 64, v2
    v_bfe_u32 v12, v0, 2, 2
    v_and_b32 v13, 1, v11
    v_lshl_or_b32 v13, v13, 2, v12
    v_lshl_add_u32 v14, v11, 3, v12
    v_lshlrev_b32 v14, 8, v14
    v_and_b32 v15, 3, v0
    v_lshl_add_u32 v14, v15, 3, v14
    v_add_u32 v14, 0x4000, v14
    s_lshl_b32 s62, s61, 2
    s_add_u32 s63, s62, 0
    v_xor_b32 v15, s63, v13
    v_lshl_add_u32 v4, v15, 5, v14
    s_add_u32 s63, s62, 1
    v_xor_b32 v15, s63, v13
    v_lshl_add_u32 v5, v15, 5, v14
    s_add_u32 s63, s62, 2
    v_xor_b32 v15, s63, v13
    v_lshl_add_u32 v6, v15, 5, v14
    s_add_u32 s63, s62, 3
    v_xor_b32 v15, s63, v13
    v_lshl_add_u32 v7, v15, 5, v14
    s_lshl_b32 s62, s52, 13
    s_add_u32 s62, s62, 131072
    v_add_u32 v8, s62, v8
    s_mov_b32 s16, s38
    s_mov_b32 s17, s39
    s_mov_b32 s18, 3072
    s_mov_b32 s19, 0x00020000
    s_lshl_b32 s62, s95, 1
    s_lshl_b32 s63, s61, 7
    s_add_u32 s62, s62, s63
    v_lshlrev_b32 v12, 3, v11
    buffer_load_dwordx2 v[208:209], v12, s[16:19], s62 offen offset:0
    buffer_load_dwordx2 v[210:211], v12, s[16:19], s62 offen offset:32
    buffer_load_dwordx2 v[212:213], v12, s[16:19], s62 offen offset:64
    buffer_load_dwordx2 v[214:215], v12, s[16:19], s62 offen offset:96
    s_mul_i32 s62, s57, 81920
    s_add_u32 s86, s62, 2621440
    s_lshl_b32 s63, s96, 2
    s_add_u32 s63, s63, s52
    s_lshl_b32 s64, s63, 9
    s_add_u32 s85, s62, s64
    s_lshl_b32 s64, s63, 8
    s_add_u32 s91, s64, 19562496
    s_add_u32 s82, s85, 0x4000
    s_add_u32 s83, s85, 0x10000
    v_and_b32 v1, 31, v0
    v_lshrrev_b32 v9, 5, v0
    v_lshlrev_b32 v12, 15, v9
    v_lshl_add_u32 v12, v1, 3, v12
    v_lshlrev_b32 v13, 3, v0
    v_lshlrev_b32 v14, 2, v1
    v_mov_b32 v15, 0
    v_bfe_u32 v10, v0, 3, 1
    v_bfe_u32 v11, v0, 4, 1
    v_xor_b32 v10, v10, v11
    v_mul_u32_u24 v10, 24, v10
    v_xor_b32 v11, v10, v0
    v_lshlrev_b32 v11, 3, v11
    v_and_b32 v10, 0xff, v11
    v_lshl_add_u32 v10, v9, 15, v10
    s_mov_b32 s79, 0
    s_mov_b32 s78, 0x7f000000
    s_cmp_eq_u32 s94, 0
    s_cselect_b32 s65, 0x40000000, 0
    v_add_u32 v12, s65, v12
    v_add_u32 v13, s65, v13
    v_add_u32 v10, s65, v10
    v_add_u32 v11, s65, v11
    v_lshlrev_b32 v232, 30, v0
    v_lshrrev_b32 v233, 2, v0
    v_lshl_or_b32 v232, v233, 26, v232
    s_mov_b32 s70, 0x7f000000
    s_waitcnt vmcnt(0)
    v_lshlrev_b32 v192, 16, v208
    v_and_b32 v193, 0xffff0000, v208
    v_lshlrev_b32 v194, 16, v209
    v_and_b32 v195, 0xffff0000, v209
    v_lshlrev_b32 v196, 16, v210
    v_and_b32 v197, 0xffff0000, v210
    v_lshlrev_b32 v198, 16, v211
    v_and_b32 v199, 0xffff0000, v211
    v_lshlrev_b32 v200, 16, v212
    v_and_b32 v201, 0xffff0000, v212
    v_lshlrev_b32 v202, 16, v213
    v_and_b32 v203, 0xffff0000, v213
    v_lshlrev_b32 v204, 16, v214
    v_and_b32 v205, 0xffff0000, v214
    v_lshlrev_b32 v206, 16, v215
    v_and_b32 v207, 0xffff0000, v215
    v_mov_b64 v[208:209], 0
    v_mov_b64 v[210:211], 0
    v_mov_b64 v[212:213], 0
    v_mov_b64 v[214:215], 0
    s_barrier
    ds_read_b128 v[128:131], v2 offset:0
    ds_read_b64_tr_b16 v[144:145], v4 offset:0
    ds_read_b64_tr_b16 v[146:147], v4 offset:1024
    ds_read_b128 v[132:135], v2 offset:2048
    ds_read_b64_tr_b16 v[148:149], v5 offset:0
    ds_read_b64_tr_b16 v[150:151], v5 offset:1024
    ds_read_b128 v[136:139], v2 offset:4096
    ds_read_b64_tr_b16 v[152:153], v6 offset:0
    ds_read_b64_tr_b16 v[154:155], v6 offset:1024
    ds_read_b128 v[140:143], v2 offset:6144
    ds_read_b64_tr_b16 v[156:157], v7 offset:0
    ds_read_b64_tr_b16 v[158:159], v7 offset:1024
    buffer_load_dwordx2 v[234:235], v15, s[24:27], 0 offen sc1
    s_cmp_eq_u32 s55, 2
    s_cbranch_scc1 LA_roundV
    s_cmp_eq_u32 s55, 1
    s_cbranch_scc1 LA_round2
    s_waitcnt lgkmcnt(0)
    v_mfma_f32_16x16x32_bf16 v[16:19], v[144:147], v[128:131], 0
    ds_read_b128 v[160:163], v3 offset:0
    ds_read_b64_tr_b16 v[176:177], v4 offset:8192
    v_mfma_f32_16x16x32_bf16 v[20:23], v[144:147], v[132:135], 0
    ds_read_b64_tr_b16 v[178:179], v4 offset:9216
    v_mfma_f32_16x16x32_bf16 v[24:27], v[144:147], v[136:139], 0
    ds_read_b128 v[164:167], v3 offset:2048
    ds_read_b64_tr_b16 v[180:181], v5 offset:8192
    v_mfma_f32_16x16x32_bf16 v[28:31], v[144:147], v[140:143], 0
    ds_read_b64_tr_b16 v[182:183], v5 offset:9216
    v_mfma_f32_16x16x32_bf16 v[32:35], v[148:151], v[128:131], 0
    ds_read_b128 v[168:171], v3 offset:4096
    ds_read_b64_tr_b16 v[184:185], v6 offset:8192
    v_mfma_f32_16x16x32_bf16 v[36:39], v[148:151], v[132:135], 0
    ds_read_b64_tr_b16 v[186:187], v6 offset:9216
    v_mfma_f32_16x16x32_bf16 v[40:43], v[148:151], v[136:139], 0
    ds_read_b128 v[172:175], v3 offset:6144
    ds_read_b64_tr_b16 v[188:189], v7 offset:8192
    v_mfma_f32_16x16x32_bf16 v[44:47], v[148:151], v[140:143], 0
    ds_read_b64_tr_b16 v[190:191], v7 offset:9216
    v_mfma_f32_16x16x32_bf16 v[48:51], v[152:155], v[128:131], 0
    s_lshr_b32 s60, s52, 1
    v_mfma_f32_16x16x32_bf16 v[52:55], v[152:155], v[132:135], 0
    s_and_b32 s61, s52, 1
    v_and_b32 v216, 15, v0
    v_mfma_f32_16x16x32_bf16 v[56:59], v[152:155], v[136:139], 0
    v_lshrrev_b32 v217, 4, v0
    v_mfma_f32_16x16x32_bf16 v[60:63], v[152:155], v[140:143], 0
    s_cmp_lt_u32 s56, 640
    s_cselect_b32 s66, 0x3ea52b5c, 1.0
    v_mfma_f32_16x16x32_bf16 v[236:239], v[156:159], v[128:131], 0
    s_mov_b32 s67, s66
    v_mfma_f32_16x16x32_bf16 v[240:243], v[156:159], v[132:135], 0
    s_lshr_b32 s62, s56, 2
    s_lshl_b32 s63, s61, 4
    v_mfma_f32_16x16x32_bf16 v[244:247], v[156:159], v[136:139], 0
    s_add_u32 s62, s62, s63
    v_mfma_f32_16x16x32_bf16 v[248:251], v[156:159], v[140:143], 0
    s_lshl_b32 s62, s62, 14
    s_waitcnt lgkmcnt(0)
    s_barrier
    v_mfma_f32_16x16x32_bf16 v[16:19], v[176:179], v[160:163], v[16:19]
    ds_read_b128 v[128:131], v2 offset:32768
    ds_read_b64_tr_b16 v[144:145], v4 offset:32768
    v_mfma_f32_16x16x32_bf16 v[20:23], v[176:179], v[164:167], v[20:23]
    ds_read_b64_tr_b16 v[146:147], v4 offset:33792
    v_mfma_f32_16x16x32_bf16 v[24:27], v[176:179], v[168:171], v[24:27]
    ds_read_b128 v[132:135], v2 offset:34816
    ds_read_b64_tr_b16 v[148:149], v5 offset:32768
    v_mfma_f32_16x16x32_bf16 v[28:31], v[176:179], v[172:175], v[28:31]
    ds_read_b64_tr_b16 v[150:151], v5 offset:33792
    v_mfma_f32_16x16x32_bf16 v[32:35], v[180:183], v[160:163], v[32:35]
    ds_read_b128 v[136:139], v2 offset:36864
    ds_read_b64_tr_b16 v[152:153], v6 offset:32768
    v_mfma_f32_16x16x32_bf16 v[36:39], v[180:183], v[164:167], v[36:39]
    ds_read_b64_tr_b16 v[154:155], v6 offset:33792
    v_mfma_f32_16x16x32_bf16 v[40:43], v[180:183], v[168:171], v[40:43]
    ds_read_b128 v[140:143], v2 offset:38912
    ds_read_b64_tr_b16 v[156:157], v7 offset:32768
    v_mfma_f32_16x16x32_bf16 v[44:47], v[180:183], v[172:175], v[44:47]
    ds_read_b64_tr_b16 v[158:159], v7 offset:33792
    v_mfma_f32_16x16x32_bf16 v[48:51], v[184:187], v[160:163], v[48:51]
    s_lshl_b32 s63, s53, 10
    v_mfma_f32_16x16x32_bf16 v[52:55], v[184:187], v[164:167], v[52:55]
    s_add_u32 s62, s62, s63
    s_lshl_b32 s63, s60, 9
    v_mfma_f32_16x16x32_bf16 v[56:59], v[184:187], v[168:171], v[56:59]
    s_add_u32 s70, s62, s63
    v_mfma_f32_16x16x32_bf16 v[60:63], v[184:187], v[172:175], v[60:63]
    v_lshlrev_b32 v218, 14, v217
    v_lshl_add_u32 v218, v216, 4, v218
    v_mfma_f32_16x16x32_bf16 v[236:239], v[188:191], v[160:163], v[236:239]
    v_add_u32 v208, 0, v218
    v_mfma_f32_16x16x32_bf16 v[240:243], v[188:191], v[164:167], v[240:243]
    v_add_u32 v209, 256, v218
    v_add_u32 v210, 65536, v218
    v_mfma_f32_16x16x32_bf16 v[244:247], v[188:191], v[168:171], v[244:247]
    v_add_u32 v211, 65792, v218
    v_mfma_f32_16x16x32_bf16 v[248:251], v[188:191], v[172:175], v[248:251]
    v_add_u32 v212, 131072, v218
    s_waitcnt lgkmcnt(0)
    v_mfma_f32_16x16x32_bf16 v[16:19], v[144:147], v[128:131], v[16:19]
    ds_read_b128 v[160:163], v3 offset:32768
    ds_read_b64_tr_b16 v[176:177], v4 offset:40960
    v_mfma_f32_16x16x32_bf16 v[20:23], v[144:147], v[132:135], v[20:23]
    ds_read_b64_tr_b16 v[178:179], v4 offset:41984
    v_mfma_f32_16x16x32_bf16 v[24:27], v[144:147], v[136:139], v[24:27]
    ds_read_b128 v[164:167], v3 offset:34816
    ds_read_b64_tr_b16 v[180:181], v5 offset:40960
    v_mfma_f32_16x16x32_bf16 v[28:31], v[144:147], v[140:143], v[28:31]
    ds_read_b64_tr_b16 v[182:183], v5 offset:41984
    v_mfma_f32_16x16x32_bf16 v[32:35], v[148:151], v[128:131], v[32:35]
    ds_read_b128 v[168:171], v3 offset:36864
    ds_read_b64_tr_b16 v[184:185], v6 offset:40960
    v_mfma_f32_16x16x32_bf16 v[36:39], v[148:151], v[132:135], v[36:39]
    ds_read_b64_tr_b16 v[186:187], v6 offset:41984
    v_mfma_f32_16x16x32_bf16 v[40:43], v[148:151], v[136:139], v[40:43]
    ds_read_b128 v[172:175], v3 offset:38912
    ds_read_b64_tr_b16 v[188:189], v7 offset:40960
    v_mfma_f32_16x16x32_bf16 v[44:47], v[148:151], v[140:143], v[44:47]
    ds_read_b64_tr_b16 v[190:191], v7 offset:41984
    v_mfma_f32_16x16x32_bf16 v[48:51], v[152:155], v[128:131], v[48:51]
    v_add_u32 v213, 131328, v218
    v_mfma_f32_16x16x32_bf16 v[52:55], v[152:155], v[132:135], v[52:55]
    v_add_u32 v214, 196608, v218
    v_add_u32 v215, 196864, v218
    v_mfma_f32_16x16x32_bf16 v[56:59], v[152:155], v[136:139], v[56:59]
    s_lshl_b32 s62, s54, 4
    v_mfma_f32_16x16x32_bf16 v[60:63], v[152:155], v[140:143], v[60:63]
    s_add_u32 s62, s62, s53
    s_lshl_b32 s62, s62, 4
    v_mfma_f32_16x16x32_bf16 v[236:239], v[156:159], v[128:131], v[236:239]
    s_lshl_b32 s63, s61, 1
    v_mfma_f32_16x16x32_bf16 v[240:243], v[156:159], v[132:135], v[240:243]
    s_add_u32 s62, s62, s63
    s_add_u32 s62, s62, s60
    v_mfma_f32_16x16x32_bf16 v[244:247], v[156:159], v[136:139], v[244:247]
    s_lshl_b32 s62, s62, 3
    v_mfma_f32_16x16x32_bf16 v[248:251], v[156:159], v[140:143], v[248:251]
    s_add_u32 s78, s62, 19578880
    s_waitcnt lgkmcnt(0)
    s_barrier
    v_mfma_f32_16x16x32_bf16 v[16:19], v[176:179], v[160:163], v[16:19]
    v_xor_b32 v2, 0x10000, v2
    v_xor_b32 v3, 0x10000, v3
    v_mfma_f32_16x16x32_bf16 v[20:23], v[176:179], v[164:167], v[20:23]
    v_xor_b32 v4, 0x10000, v4
    v_xor_b32 v5, 0x10000, v5
    v_mfma_f32_16x16x32_bf16 v[24:27], v[176:179], v[168:171], v[24:27]
    v_xor_b32 v6, 0x10000, v6
    v_xor_b32 v7, 0x10000, v7
    v_mfma_f32_16x16x32_bf16 v[28:31], v[176:179], v[172:175], v[28:31]
    ds_read_b128 v[128:131], v2 offset:0
    v_mfma_f32_16x16x32_bf16 v[32:35], v[180:183], v[160:163], v[32:35]
    ds_read_b64_tr_b16 v[144:145], v4 offset:0
    v_mfma_f32_16x16x32_bf16 v[36:39], v[180:183], v[164:167], v[36:39]
    ds_read_b64_tr_b16 v[146:147], v4 offset:1024
    v_mfma_f32_16x16x32_bf16 v[40:43], v[180:183], v[168:171], v[40:43]
    ds_read_b128 v[132:135], v2 offset:2048
    v_mfma_f32_16x16x32_bf16 v[44:47], v[180:183], v[172:175], v[44:47]
    ds_read_b64_tr_b16 v[148:149], v5 offset:0
    v_mfma_f32_16x16x32_bf16 v[48:51], v[184:187], v[160:163], v[48:51]
    ds_read_b64_tr_b16 v[150:151], v5 offset:1024
    v_mfma_f32_16x16x32_bf16 v[52:55], v[184:187], v[164:167], v[52:55]
    ds_read_b128 v[136:139], v2 offset:4096
    v_mfma_f32_16x16x32_bf16 v[56:59], v[184:187], v[168:171], v[56:59]
    ds_read_b64_tr_b16 v[152:153], v6 offset:0
    v_mfma_f32_16x16x32_bf16 v[60:63], v[184:187], v[172:175], v[60:63]
    ds_read_b64_tr_b16 v[154:155], v6 offset:1024
    v_mfma_f32_16x16x32_bf16 v[236:239], v[188:191], v[160:163], v[236:239]
    ds_read_b128 v[140:143], v2 offset:6144
    v_mfma_f32_16x16x32_bf16 v[240:243], v[188:191], v[164:167], v[240:243]
    ds_read_b64_tr_b16 v[156:157], v7 offset:0
    v_mfma_f32_16x16x32_bf16 v[244:247], v[188:191], v[168:171], v[244:247]
    ds_read_b64_tr_b16 v[158:159], v7 offset:1024
    v_mfma_f32_16x16x32_bf16 v[248:251], v[188:191], v[172:175], v[248:251]
    s_add_u32 s58, s94, 3
LA_loopN:
    s_waitcnt lgkmcnt(0)
    v_mfma_f32_16x16x32_bf16 v[16:19], v[144:147], v[128:131], v[16:19]
    ds_read_b128 v[160:163], v3 offset:0
    v_mfma_f32_16x16x32_bf16 v[20:23], v[144:147], v[132:135], v[20:23]
    ds_read_b64_tr_b16 v[176:177], v4 offset:8192
    v_mfma_f32_16x16x32_bf16 v[24:27], v[144:147], v[136:139], v[24:27]
    ds_read_b64_tr_b16 v[178:179], v4 offset:9216
    v_mfma_f32_16x16x32_bf16 v[28:31], v[144:147], v[140:143], v[28:31]
    ds_read_b128 v[164:167], v3 offset:2048
    v_mfma_f32_16x16x32_bf16 v[32:35], v[148:151], v[128:131], v[32:35]
    ds_read_b64_tr_b16 v[180:181], v5 offset:8192
    v_mfma_f32_16x16x32_bf16 v[36:39], v[148:151], v[132:135], v[36:39]
    ds_read_b64_tr_b16 v[182:183], v5 offset:9216
    v_mfma_f32_16x16x32_bf16 v[40:43], v[148:151], v[136:139], v[40:43]
    ds_read_b128 v[168:171], v3 offset:4096
    v_mfma_f32_16x16x32_bf16 v[44:47], v[148:151], v[140:143], v[44:47]
    ds_read_b64_tr_b16 v[184:185], v6 offset:8192
    v_mfma_f32_16x16x32_bf16 v[48:51], v[152:155], v[128:131], v[48:51]
    ds_read_b64_tr_b16 v[186:187], v6 offset:9216
    v_mfma_f32_16x16x32_bf16 v[52:55], v[152:155], v[132:135], v[52:55]
    ds_read_b128 v[172:175], v3 offset:6144
    v_mfma_f32_16x16x32_bf16 v[56:59], v[152:155], v[136:139], v[56:59]
    ds_read_b64_tr_b16 v[188:189], v7 offset:8192
    v_mfma_f32_16x16x32_bf16 v[60:63], v[152:155], v[140:143], v[60:63]
    ds_read_b64_tr_b16 v[190:191], v7 offset:9216
    v_mfma_f32_16x16x32_bf16 v[236:239], v[156:159], v[128:131], v[236:239]
    v_mfma_f32_16x16x32_bf16 v[240:243], v[156:159], v[132:135], v[240:243]
    v_mfma_f32_16x16x32_bf16 v[244:247], v[156:159], v[136:139], v[244:247]
    v_mfma_f32_16x16x32_bf16 v[248:251], v[156:159], v[140:143], v[248:251]
    s_waitcnt lgkmcnt(0)
    s_barrier
    v_mfma_f32_16x16x32_bf16 v[16:19], v[176:179], v[160:163], v[16:19]
    ds_read_b128 v[128:131], v2 offset:32768
    v_mfma_f32_16x16x32_bf16 v[20:23], v[176:179], v[164:167], v[20:23]
    ds_read_b64_tr_b16 v[144:145], v4 offset:32768
    v_mfma_f32_16x16x32_bf16 v[24:27], v[176:179], v[168:171], v[24:27]
    ds_read_b64_tr_b16 v[146:147], v4 offset:33792
    v_mfma_f32_16x16x32_bf16 v[28:31], v[176:179], v[172:175], v[28:31]
    ds_read_b128 v[132:135], v2 offset:34816
    v_mfma_f32_16x16x32_bf16 v[32:35], v[180:183], v[160:163], v[32:35]
    ds_read_b64_tr_b16 v[148:149], v5 offset:32768
    v_mfma_f32_16x16x32_bf16 v[36:39], v[180:183], v[164:167], v[36:39]
    ds_read_b64_tr_b16 v[150:151], v5 offset:33792
    v_mfma_f32_16x16x32_bf16 v[40:43], v[180:183], v[168:171], v[40:43]
    ds_read_b128 v[136:139], v2 offset:36864
    v_mfma_f32_16x16x32_bf16 v[44:47], v[180:183], v[172:175], v[44:47]
    ds_read_b64_tr_b16 v[152:153], v6 offset:32768
    v_mfma_f32_16x16x32_bf16 v[48:51], v[184:187], v[160:163], v[48:51]
    ds_read_b64_tr_b16 v[154:155], v6 offset:33792
    v_mfma_f32_16x16x32_bf16 v[52:55], v[184:187], v[164:167], v[52:55]
    ds_read_b128 v[140:143], v2 offset:38912
    v_mfma_f32_16x16x32_bf16 v[56:59], v[184:187], v[168:171], v[56:59]
    ds_read_b64_tr_b16 v[156:157], v7 offset:32768
    v_mfma_f32_16x16x32_bf16 v[60:63], v[184:187], v[172:175], v[60:63]
    ds_read_b64_tr_b16 v[158:159], v7 offset:33792
    v_mfma_f32_16x16x32_bf16 v[236:239], v[188:191], v[160:163], v[236:239]
    v_mfma_f32_16x16x32_bf16 v[240:243], v[188:191], v[164:167], v[240:243]
    v_mfma_f32_16x16x32_bf16 v[244:247], v[188:191], v[168:171], v[244:247]
    v_mfma_f32_16x16x32_bf16 v[248:251], v[188:191], v[172:175], v[248:251]
    s_waitcnt lgkmcnt(0)
    v_mfma_f32_16x16x32_bf16 v[16:19], v[144:147], v[128:131], v[16:19]
    ds_read_b128 v[160:163], v3 offset:32768
    v_mfma_f32_16x16x32_bf16 v[20:23], v[144:147], v[132:135], v[20:23]
    ds_read_b64_tr_b16 v[176:177], v4 offset:40960
    v_mfma_f32_16x16x32_bf16 v[24:27], v[144:147], v[136:139], v[24:27]
    ds_read_b64_tr_b16 v[178:179], v4 offset:41984
    v_mfma_f32_16x16x32_bf16 v[28:31], v[144:147], v[140:143], v[28:31]
    ds_read_b128 v[164:167], v3 offset:34816
    v_mfma_f32_16x16x32_bf16 v[32:35], v[148:151], v[128:131], v[32:35]
    ds_read_b64_tr_b16 v[180:181], v5 offset:40960
    v_mfma_f32_16x16x32_bf16 v[36:39], v[148:151], v[132:135], v[36:39]
    ds_read_b64_tr_b16 v[182:183], v5 offset:41984
    v_mfma_f32_16x16x32_bf16 v[40:43], v[148:151], v[136:139], v[40:43]
    ds_read_b128 v[168:171], v3 offset:36864
    v_mfma_f32_16x16x32_bf16 v[44:47], v[148:151], v[140:143], v[44:47]
    ds_read_b64_tr_b16 v[184:185], v6 offset:40960
    v_mfma_f32_16x16x32_bf16 v[48:51], v[152:155], v[128:131], v[48:51]
    ds_read_b64_tr_b16 v[186:187], v6 offset:41984
    v_mfma_f32_16x16x32_bf16 v[52:55], v[152:155], v[132:135], v[52:55]
    ds_read_b128 v[172:175], v3 offset:38912
    v_mfma_f32_16x16x32_bf16 v[56:59], v[152:155], v[136:139], v[56:59]
    ds_read_b64_tr_b16 v[188:189], v7 offset:40960
    v_mfma_f32_16x16x32_bf16 v[60:63], v[152:155], v[140:143], v[60:63]
    ds_read_b64_tr_b16 v[190:191], v7 offset:41984
    v_mfma_f32_16x16x32_bf16 v[236:239], v[156:159], v[128:131], v[236:239]
    v_mfma_f32_16x16x32_bf16 v[240:243], v[156:159], v[132:135], v[240:243]
    v_mfma_f32_16x16x32_bf16 v[244:247], v[156:159], v[136:139], v[244:247]
    v_mfma_f32_16x16x32_bf16 v[248:251], v[156:159], v[140:143], v[248:251]
    s_waitcnt lgkmcnt(0)
    s_barrier
    v_mfma_f32_16x16x32_bf16 v[16:19], v[176:179], v[160:163], v[16:19]
    v_xor_b32 v2, 0x10000, v2
    v_xor_b32 v3, 0x10000, v3
    v_mfma_f32_16x16x32_bf16 v[20:23], v[176:179], v[164:167], v[20:23]
    v_xor_b32 v4, 0x10000, v4
    v_xor_b32 v5, 0x10000, v5
    v_mfma_f32_16x16x32_bf16 v[24:27], v[176:179], v[168:171], v[24:27]
    v_xor_b32 v6, 0x10000, v6
    v_xor_b32 v7, 0x10000, v7
    v_mfma_f32_16x16x32_bf16 v[28:31], v[176:179], v[172:175], v[28:31]
    ds_read_b128 v[128:131], v2 offset:0
    v_mfma_f32_16x16x32_bf16 v[32:35], v[180:183], v[160:163], v[32:35]
    ds_read_b64_tr_b16 v[144:145], v4 offset:0
    v_mfma_f32_16x16x32_bf16 v[36:39], v[180:183], v[164:167], v[36:39]
    ds_read_b64_tr_b16 v[146:147], v4 offset:1024
    v_mfma_f32_16x16x32_bf16 v[40:43], v[180:183], v[168:171], v[40:43]
    ds_read_b128 v[132:135], v2 offset:2048
    v_mfma_f32_16x16x32_bf16 v[44:47], v[180:183], v[172:175], v[44:47]
    ds_read_b64_tr_b16 v[148:149], v5 offset:0
    v_mfma_f32_16x16x32_bf16 v[48:51], v[184:187], v[160:163], v[48:51]
    ds_read_b64_tr_b16 v[150:151], v5 offset:1024
    v_mfma_f32_16x16x32_bf16 v[52:55], v[184:187], v[164:167], v[52:55]
    ds_read_b128 v[136:139], v2 offset:4096
    v_mfma_f32_16x16x32_bf16 v[56:59], v[184:187], v[168:171], v[56:59]
    ds_read_b64_tr_b16 v[152:153], v6 offset:0
    v_mfma_f32_16x16x32_bf16 v[60:63], v[184:187], v[172:175], v[60:63]
    ds_read_b64_tr_b16 v[154:155], v6 offset:1024
    v_mfma_f32_16x16x32_bf16 v[236:239], v[188:191], v[160:163], v[236:239]
    ds_read_b128 v[140:143], v2 offset:6144
    v_mfma_f32_16x16x32_bf16 v[240:243], v[188:191], v[164:167], v[240:243]
    ds_read_b64_tr_b16 v[156:157], v7 offset:0
    v_mfma_f32_16x16x32_bf16 v[244:247], v[188:191], v[168:171], v[244:247]
    ds_read_b64_tr_b16 v[158:159], v7 offset:1024
    v_mfma_f32_16x16x32_bf16 v[248:251], v[188:191], v[172:175], v[248:251]
    s_sub_u32 s58, s58, 1
    s_cmp_lg_u32 s58, 0
    s_cbranch_scc1 LA_loopN
    s_mov_b32 s79, 1
    s_cmp_lg_u32 s94, 0
    s_cbranch_scc1 LA_round2
    s_waitcnt lgkmcnt(0)
    v_mfma_f32_16x16x32_bf16 v[16:19], v[144:147], v[128:131], v[16:19]
    ds_read_b128 v[160:163], v3 offset:0
    v_mfma_f32_16x16x32_bf16 v[20:23], v[144:147], v[132:135], v[20:23]
    ds_read_b64_tr_b16 v[176:177], v4 offset:8192
    v_mfma_f32_16x16x32_bf16 v[24:27], v[144:147], v[136:139], v[24:27]
    ds_read_b64_tr_b16 v[178:179], v4 offset:9216
    v_mfma_f32_16x16x32_bf16 v[28:31], v[144:147], v[140:143], v[28:31]
    ds_read_b128 v[164:167], v3 offset:2048
    v_mfma_f32_16x16x32_bf16 v[32:35], v[148:151], v[128:131], v[32:35]
    ds_read_b64_tr_b16 v[180:181], v5 offset:8192
    v_mfma_f32_16x16x32_bf16 v[36:39], v[148:151], v[132:135], v[36:39]
    ds_read_b64_tr_b16 v[182:183], v5 offset:9216
    v_mfma_f32_16x16x32_bf16 v[40:43], v[148:151], v[136:139], v[40:43]
    ds_read_b128 v[168:171], v3 offset:4096
    v_mfma_f32_16x16x32_bf16 v[44:47], v[148:151], v[140:143], v[44:47]
    ds_read_b64_tr_b16 v[184:185], v6 offset:8192
    v_mfma_f32_16x16x32_bf16 v[48:51], v[152:155], v[128:131], v[48:51]
    ds_read_b64_tr_b16 v[186:187], v6 offset:9216
    v_mfma_f32_16x16x32_bf16 v[52:55], v[152:155], v[132:135], v[52:55]
    ds_read_b128 v[172:175], v3 offset:6144
    v_mfma_f32_16x16x32_bf16 v[56:59], v[152:155], v[136:139], v[56:59]
    ds_read_b64_tr_b16 v[188:189], v7 offset:8192
    v_mfma_f32_16x16x32_bf16 v[60:63], v[152:155], v[140:143], v[60:63]
    ds_read_b64_tr_b16 v[190:191], v7 offset:9216
    v_mfma_f32_16x16x32_bf16 v[236:239], v[156:159], v[128:131], v[236:239]
    v_mfma_f32_16x16x32_bf16 v[240:243], v[156:159], v[132:135], v[240:243]
    v_mfma_f32_16x16x32_bf16 v[244:247], v[156:159], v[136:139], v[244:247]
    v_mfma_f32_16x16x32_bf16 v[248:251], v[156:159], v[140:143], v[248:251]
    s_waitcnt lgkmcnt(0)
    s_barrier
    v_mfma_f32_16x16x32_bf16 v[16:19], v[176:179], v[160:163], v[16:19]
    ds_read_b128 v[128:131], v2 offset:32768
    v_mfma_f32_16x16x32_bf16 v[20:23], v[176:179], v[164:167], v[20:23]
    ds_read_b64_tr_b16 v[144:145], v4 offset:32768
    v_mfma_f32_16x16x32_bf16 v[24:27], v[176:179], v[168:171], v[24:27]
    ds_read_b64_tr_b16 v[146:147], v4 offset:33792
    v_mfma_f32_16x16x32_bf16 v[28:31], v[176:179], v[172:175], v[28:31]
    ds_read_b128 v[132:135], v2 offset:34816
    v_mfma_f32_16x16x32_bf16 v[32:35], v[180:183], v[160:163], v[32:35]
    ds_read_b64_tr_b16 v[148:149], v5 offset:32768
    v_mfma_f32_16x16x32_bf16 v[36:39], v[180:183], v[164:167], v[36:39]
    ds_read_b64_tr_b16 v[150:151], v5 offset:33792
    v_mfma_f32_16x16x32_bf16 v[40:43], v[180:183], v[168:171], v[40:43]
    ds_read_b128 v[136:139], v2 offset:36864
    v_mfma_f32_16x16x32_bf16 v[44:47], v[180:183], v[172:175], v[44:47]
    ds_read_b64_tr_b16 v[152:153], v6 offset:32768
    v_mfma_f32_16x16x32_bf16 v[48:51], v[184:187], v[160:163], v[48:51]
    ds_read_b64_tr_b16 v[154:155], v6 offset:33792
    v_mfma_f32_16x16x32_bf16 v[52:55], v[184:187], v[164:167], v[52:55]
    ds_read_b128 v[140:143], v2 offset:38912
    v_mfma_f32_16x16x32_bf16 v[56:59], v[184:187], v[168:171], v[56:59]
    ds_read_b64_tr_b16 v[156:157], v7 offset:32768
    v_mfma_f32_16x16x32_bf16 v[60:63], v[184:187], v[172:175], v[60:63]
    ds_read_b64_tr_b16 v[158:159], v7 offset:33792
    v_mfma_f32_16x16x32_bf16 v[236:239], v[188:191], v[160:163], v[236:239]
    v_mfma_f32_16x16x32_bf16 v[240:243], v[188:191], v[164:167], v[240:243]
    v_mfma_f32_16x16x32_bf16 v[244:247], v[188:191], v[168:171], v[244:247]
    v_mfma_f32_16x16x32_bf16 v[248:251], v[188:191], v[172:175], v[248:251]
    s_waitcnt lgkmcnt(0)
    v_mfma_f32_16x16x32_bf16 v[16:19], v[144:147], v[128:131], v[16:19]
    ds_read_b128 v[160:163], v3 offset:32768
    v_mfma_f32_16x16x32_bf16 v[20:23], v[144:147], v[132:135], v[20:23]
    ds_read_b64_tr_b16 v[176:177], v4 offset:40960
    v_mfma_f32_16x16x32_bf16 v[24:27], v[144:147], v[136:139], v[24:27]
    ds_read_b64_tr_b16 v[178:179], v4 offset:41984
    v_mfma_f32_16x16x32_bf16 v[28:31], v[144:147], v[140:143], v[28:31]
    ds_read_b128 v[164:167], v3 offset:34816
    v_mfma_f32_16x16x32_bf16 v[32:35], v[148:151], v[128:131], v[32:35]
    ds_read_b64_tr_b16 v[180:181], v5 offset:40960
    v_mfma_f32_16x16x32_bf16 v[36:39], v[148:151], v[132:135], v[36:39]
    ds_read_b64_tr_b16 v[182:183], v5 offset:41984
    v_mfma_f32_16x16x32_bf16 v[40:43], v[148:151], v[136:139], v[40:43]
    ds_read_b128 v[168:171], v3 offset:36864
    v_mfma_f32_16x16x32_bf16 v[44:47], v[148:151], v[140:143], v[44:47]
    ds_read_b64_tr_b16 v[184:185], v6 offset:40960
    v_mfma_f32_16x16x32_bf16 v[48:51], v[152:155], v[128:131], v[48:51]
    ds_read_b64_tr_b16 v[186:187], v6 offset:41984
    v_mfma_f32_16x16x32_bf16 v[52:55], v[152:155], v[132:135], v[52:55]
    ds_read_b128 v[172:175], v3 offset:38912
    v_mfma_f32_16x16x32_bf16 v[56:59], v[152:155], v[136:139], v[56:59]
    ds_read_b64_tr_b16 v[188:189], v7 offset:40960
    v_mfma_f32_16x16x32_bf16 v[60:63], v[152:155], v[140:143], v[60:63]
    ds_read_b64_tr_b16 v[190:191], v7 offset:41984
    v_mfma_f32_16x16x32_bf16 v[236:239], v[156:159], v[128:131], v[236:239]
    v_mfma_f32_16x16x32_bf16 v[240:243], v[156:159], v[132:135], v[240:243]
    v_mfma_f32_16x16x32_bf16 v[244:247], v[156:159], v[136:139], v[244:247]
    v_mfma_f32_16x16x32_bf16 v[248:251], v[156:159], v[140:143], v[248:251]
    s_waitcnt lgkmcnt(0)
    v_mfma_f32_16x16x32_bf16 v[16:19], v[176:179], v[160:163], v[16:19]
    v_mfma_f32_16x16x32_bf16 v[20:23], v[176:179], v[164:167], v[20:23]
    v_mfma_f32_16x16x32_bf16 v[24:27], v[176:179], v[168:171], v[24:27]
    v_mfma_f32_16x16x32_bf16 v[28:31], v[176:179], v[172:175], v[28:31]
    v_mfma_f32_16x16x32_bf16 v[32:35], v[180:183], v[160:163], v[32:35]
    v_mfma_f32_16x16x32_bf16 v[36:39], v[180:183], v[164:167], v[36:39]
    v_mfma_f32_16x16x32_bf16 v[40:43], v[180:183], v[168:171], v[40:43]
    v_mfma_f32_16x16x32_bf16 v[44:47], v[180:183], v[172:175], v[44:47]
    v_mfma_f32_16x16x32_bf16 v[48:51], v[184:187], v[160:163], v[48:51]
    v_mfma_f32_16x16x32_bf16 v[52:55], v[184:187], v[164:167], v[52:55]
    v_mfma_f32_16x16x32_bf16 v[56:59], v[184:187], v[168:171], v[56:59]
    v_mfma_f32_16x16x32_bf16 v[60:63], v[184:187], v[172:175], v[60:63]
    v_mfma_f32_16x16x32_bf16 v[236:239], v[188:191], v[160:163], v[236:239]
    v_mfma_f32_16x16x32_bf16 v[240:243], v[188:191], v[164:167], v[240:243]
    v_mfma_f32_16x16x32_bf16 v[244:247], v[188:191], v[168:171], v[244:247]
    v_mfma_f32_16x16x32_bf16 v[248:251], v[188:191], v[172:175], v[248:251]
    s_branch LA_sepi
LA_roundV:
    s_waitcnt lgkmcnt(0)
    v_mfma_f32_16x16x32_bf16 v[16:19], v[128:131], v[144:147], 0
    ds_read_b128 v[160:163], v3 offset:0
    ds_read_b64_tr_b16 v[176:177], v4 offset:8192
    v_mfma_f32_16x16x32_bf16 v[20:23], v[132:135], v[144:147], 0
    ds_read_b64_tr_b16 v[178:179], v4 offset:9216
    ds_read_b128 v[164:167], v3 offset:2048
    v_mfma_f32_16x16x32_bf16 v[24:27], v[136:139], v[144:147], 0
    ds_read_b64_tr_b16 v[180:181], v5 offset:8192
    ds_read_b64_tr_b16 v[182:183], v5 offset:9216
    v_mfma_f32_16x16x32_bf16 v[28:31], v[140:143], v[144:147], 0
    ds_read_b128 v[168:171], v3 offset:4096
    v_mfma_f32_16x16x32_bf16 v[32:35], v[128:131], v[148:151], 0
    ds_read_b64_tr_b16 v[184:185], v6 offset:8192
    ds_read_b64_tr_b16 v[186:187], v6 offset:9216
    v_mfma_f32_16x16x32_bf16 v[36:39], v[132:135], v[148:151], 0
    ds_read_b128 v[172:175], v3 offset:6144
    ds_read_b64_tr_b16 v[188:189], v7 offset:8192
    v_mfma_f32_16x16x32_bf16 v[40:43], v[136:139], v[148:151], 0
    ds_read_b64_tr_b16 v[190:191], v7 offset:9216
    s_lshr_b32 s60, s52, 1
    v_mfma_f32_16x16x32_bf16 v[44:47], v[140:143], v[148:151], 0
    s_and_b32 s61, s52, 1
    v_mfma_f32_16x16x32_bf16 v[48:51], v[128:131], v[152:155], 0
    v_and_b32 v216, 15, v0
    v_lshrrev_b32 v217, 4, v0
    v_mfma_f32_16x16x32_bf16 v[52:55], v[132:135], v[152:155], 0
    s_cmp_lt_u32 s56, 640
    s_cselect_b32 s66, 0x3ea52b5c, 1.0
    v_mfma_f32_16x16x32_bf16 v[56:59], v[136:139], v[152:155], 0
    s_mov_b32 s67, s66
    s_lshl_b32 s62, s61, 6
    v_mfma_f32_16x16x32_bf16 v[60:63], v[140:143], v[152:155], 0
    s_add_u32 s62, s62, s56
    v_mfma_f32_16x16x32_bf16 v[236:239], v[128:131], v[156:159], 0
    s_sub_u32 s62, s62, 1280
    v_add_u32 v216, s62, v216
    v_mfma_f32_16x16x32_bf16 v[240:243], v[132:135], v[156:159], 0
    v_mul_u32_u24 v217, 320, v217
    s_lshl_b32 s62, s53, 1
    v_mfma_f32_16x16x32_bf16 v[244:247], v[136:139], v[156:159], 0
    s_add_u32 s62, s62, s60
    s_mul_i32 s62, s62, 2560
    v_mfma_f32_16x16x32_bf16 v[248:251], v[140:143], v[156:159], 0
    s_add_u32 s70, s62, 5242880
    s_waitcnt lgkmcnt(0)
    s_barrier
    v_mfma_f32_16x16x32_bf16 v[16:19], v[160:163], v[176:179], v[16:19]
    ds_read_b128 v[128:131], v2 offset:32768
    ds_read_b64_tr_b16 v[144:145], v4 offset:32768
    v_mfma_f32_16x16x32_bf16 v[20:23], v[164:167], v[176:179], v[20:23]
    ds_read_b64_tr_b16 v[146:147], v4 offset:33792
    ds_read_b128 v[132:135], v2 offset:34816
    v_mfma_f32_16x16x32_bf16 v[24:27], v[168:171], v[176:179], v[24:27]
    ds_read_b64_tr_b16 v[148:149], v5 offset:32768
    ds_read_b64_tr_b16 v[150:151], v5 offset:33792
    v_mfma_f32_16x16x32_bf16 v[28:31], v[172:175], v[176:179], v[28:31]
    ds_read_b128 v[136:139], v2 offset:36864
    v_mfma_f32_16x16x32_bf16 v[32:35], v[160:163], v[180:183], v[32:35]
    ds_read_b64_tr_b16 v[152:153], v6 offset:32768
    ds_read_b64_tr_b16 v[154:155], v6 offset:33792
    v_mfma_f32_16x16x32_bf16 v[36:39], v[164:167], v[180:183], v[36:39]
    ds_read_b128 v[140:143], v2 offset:38912
    ds_read_b64_tr_b16 v[156:157], v7 offset:32768
    v_mfma_f32_16x16x32_bf16 v[40:43], v[168:171], v[180:183], v[40:43]
    ds_read_b64_tr_b16 v[158:159], v7 offset:33792
    s_mov_b32 s63, 81600
    v_mfma_f32_16x16x32_bf16 v[44:47], v[172:175], v[180:183], v[44:47]
    v_add_u32 v218, 0, v216
    v_mfma_f32_16x16x32_bf16 v[48:51], v[160:163], v[184:187], v[48:51]
    v_mul_u32_u24 v219, 3277, v218
    v_lshrrev_b32 v219, 16, v219
    v_mfma_f32_16x16x32_bf16 v[52:55], v[164:167], v[184:187], v[52:55]
    v_lshl_add_u32 v218, v218, 4, v217
    v_mad_u32_u24 v208, v219, s63, v218
    v_mfma_f32_16x16x32_bf16 v[56:59], v[168:171], v[184:187], v[56:59]
    v_add_u32 v209, 1280, v208
    v_add_u32 v218, 16, v216
    v_mfma_f32_16x16x32_bf16 v[60:63], v[172:175], v[184:187], v[60:63]
    v_mul_u32_u24 v219, 3277, v218
    v_mfma_f32_16x16x32_bf16 v[236:239], v[160:163], v[188:191], v[236:239]
    v_lshrrev_b32 v219, 16, v219
    v_lshl_add_u32 v218, v218, 4, v217
    v_mfma_f32_16x16x32_bf16 v[240:243], v[164:167], v[188:191], v[240:243]
    v_mad_u32_u24 v210, v219, s63, v218
    v_add_u32 v211, 1280, v210
    v_mfma_f32_16x16x32_bf16 v[244:247], v[168:171], v[188:191], v[244:247]
    v_add_u32 v218, 32, v216
    v_mul_u32_u24 v219, 3277, v218
    v_mfma_f32_16x16x32_bf16 v[248:251], v[172:175], v[188:191], v[248:251]
    v_lshrrev_b32 v219, 16, v219
    s_waitcnt lgkmcnt(0)
    v_mfma_f32_16x16x32_bf16 v[16:19], v[128:131], v[144:147], v[16:19]
    ds_read_b128 v[160:163], v3 offset:32768
    ds_read_b64_tr_b16 v[176:177], v4 offset:40960
    v_mfma_f32_16x16x32_bf16 v[20:23], v[132:135], v[144:147], v[20:23]
    ds_read_b64_tr_b16 v[178:179], v4 offset:41984
    ds_read_b128 v[164:167], v3 offset:34816
    v_mfma_f32_16x16x32_bf16 v[24:27], v[136:139], v[144:147], v[24:27]
    ds_read_b64_tr_b16 v[180:181], v5 offset:40960
    ds_read_b64_tr_b16 v[182:183], v5 offset:41984
    v_mfma_f32_16x16x32_bf16 v[28:31], v[140:143], v[144:147], v[28:31]
    ds_read_b128 v[168:171], v3 offset:36864
    ds_read_b64_tr_b16 v[184:185], v6 offset:40960
    v_mfma_f32_16x16x32_bf16 v[32:35], v[128:131], v[148:151], v[32:35]
    ds_read_b64_tr_b16 v[186:187], v6 offset:41984
    ds_read_b128 v[172:175], v3 offset:38912
    v_mfma_f32_16x16x32_bf16 v[36:39], v[132:135], v[148:151], v[36:39]
    ds_read_b64_tr_b16 v[188:189], v7 offset:40960
    v_mfma_f32_16x16x32_bf16 v[40:43], v[136:139], v[148:151], v[40:43]
    ds_read_b64_tr_b16 v[190:191], v7 offset:41984
    v_lshl_add_u32 v218, v218, 4, v217
    v_mfma_f32_16x16x32_bf16 v[44:47], v[140:143], v[148:151], v[44:47]
    v_mad_u32_u24 v212, v219, s63, v218
    v_add_u32 v213, 1280, v212
    v_mfma_f32_16x16x32_bf16 v[48:51], v[128:131], v[152:155], v[48:51]
    v_add_u32 v218, 48, v216
    v_mul_u32_u24 v219, 3277, v218
    v_mfma_f32_16x16x32_bf16 v[52:55], v[132:135], v[152:155], v[52:55]
    v_lshrrev_b32 v219, 16, v219
    v_lshl_add_u32 v218, v218, 4, v217
    v_mfma_f32_16x16x32_bf16 v[56:59], v[136:139], v[152:155], v[56:59]
    v_mad_u32_u24 v214, v219, s63, v218
    v_mfma_f32_16x16x32_bf16 v[60:63], v[140:143], v[152:155], v[60:63]
    v_add_u32 v215, 1280, v214
    s_lshl_b32 s62, s54, 4
    v_mfma_f32_16x16x32_bf16 v[236:239], v[128:131], v[156:159], v[236:239]
    s_add_u32 s62, s62, s53
    s_lshl_b32 s62, s62, 4
    v_mfma_f32_16x16x32_bf16 v[240:243], v[132:135], v[156:159], v[240:243]
    s_lshl_b32 s63, s61, 1
    s_add_u32 s62, s62, s63
    v_mfma_f32_16x16x32_bf16 v[244:247], v[136:139], v[156:159], v[244:247]
    s_add_u32 s62, s62, s60
    s_lshl_b32 s62, s62, 3
    v_mfma_f32_16x16x32_bf16 v[248:251], v[140:143], v[156:159], v[248:251]
    s_add_u32 s78, s62, 19578880
    s_waitcnt lgkmcnt(0)
    s_barrier
    v_mfma_f32_16x16x32_bf16 v[16:19], v[160:163], v[176:179], v[16:19]
    v_xor_b32 v2, 0x10000, v2
    v_xor_b32 v3, 0x10000, v3
    v_mfma_f32_16x16x32_bf16 v[20:23], v[164:167], v[176:179], v[20:23]
    v_xor_b32 v4, 0x10000, v4
    v_xor_b32 v5, 0x10000, v5
    v_mfma_f32_16x16x32_bf16 v[24:27], v[168:171], v[176:179], v[24:27]
    v_xor_b32 v6, 0x10000, v6
    v_xor_b32 v7, 0x10000, v7
    v_mfma_f32_16x16x32_bf16 v[28:31], v[172:175], v[176:179], v[28:31]
    ds_read_b128 v[128:131], v2 offset:0
    v_mfma_f32_16x16x32_bf16 v[32:35], v[160:163], v[180:183], v[32:35]
    ds_read_b64_tr_b16 v[144:145], v4 offset:0
    v_mfma_f32_16x16x32_bf16 v[36:39], v[164:167], v[180:183], v[36:39]
    ds_read_b64_tr_b16 v[146:147], v4 offset:1024
    v_mfma_f32_16x16x32_bf16 v[40:43], v[168:171], v[180:183], v[40:43]
    ds_read_b128 v[132:135], v2 offset:2048
    v_mfma_f32_16x16x32_bf16 v[44:47], v[172:175], v[180:183], v[44:47]
    ds_read_b64_tr_b16 v[148:149], v5 offset:0
    v_mfma_f32_16x16x32_bf16 v[48:51], v[160:163], v[184:187], v[48:51]
    ds_read_b64_tr_b16 v[150:151], v5 offset:1024
    v_mfma_f32_16x16x32_bf16 v[52:55], v[164:167], v[184:187], v[52:55]
    ds_read_b128 v[136:139], v2 offset:4096
    v_mfma_f32_16x16x32_bf16 v[56:59], v[168:171], v[184:187], v[56:59]
    ds_read_b64_tr_b16 v[152:153], v6 offset:0
    v_mfma_f32_16x16x32_bf16 v[60:63], v[172:175], v[184:187], v[60:63]
    ds_read_b64_tr_b16 v[154:155], v6 offset:1024
    v_mfma_f32_16x16x32_bf16 v[236:239], v[160:163], v[188:191], v[236:239]
    ds_read_b128 v[140:143], v2 offset:6144
    v_mfma_f32_16x16x32_bf16 v[240:243], v[164:167], v[188:191], v[240:243]
    ds_read_b64_tr_b16 v[156:157], v7 offset:0
    v_mfma_f32_16x16x32_bf16 v[244:247], v[168:171], v[188:191], v[244:247]
    ds_read_b64_tr_b16 v[158:159], v7 offset:1024
    v_mfma_f32_16x16x32_bf16 v[248:251], v[172:175], v[188:191], v[248:251]
    s_add_u32 s58, s94, 3
LA_loopV:
    s_waitcnt lgkmcnt(0)
    v_mfma_f32_16x16x32_bf16 v[16:19], v[128:131], v[144:147], v[16:19]
    ds_read_b128 v[160:163], v3 offset:0
    v_mfma_f32_16x16x32_bf16 v[20:23], v[132:135], v[144:147], v[20:23]
    ds_read_b64_tr_b16 v[176:177], v4 offset:8192
    v_mfma_f32_16x16x32_bf16 v[24:27], v[136:139], v[144:147], v[24:27]
    ds_read_b64_tr_b16 v[178:179], v4 offset:9216
    v_mfma_f32_16x16x32_bf16 v[28:31], v[140:143], v[144:147], v[28:31]
    ds_read_b128 v[164:167], v3 offset:2048
    v_mfma_f32_16x16x32_bf16 v[32:35], v[128:131], v[148:151], v[32:35]
    ds_read_b64_tr_b16 v[180:181], v5 offset:8192
    v_mfma_f32_16x16x32_bf16 v[36:39], v[132:135], v[148:151], v[36:39]
    ds_read_b64_tr_b16 v[182:183], v5 offset:9216
    v_mfma_f32_16x16x32_bf16 v[40:43], v[136:139], v[148:151], v[40:43]
    ds_read_b128 v[168:171], v3 offset:4096
    v_mfma_f32_16x16x32_bf16 v[44:47], v[140:143], v[148:151], v[44:47]
    ds_read_b64_tr_b16 v[184:185], v6 offset:8192
    v_mfma_f32_16x16x32_bf16 v[48:51], v[128:131], v[152:155], v[48:51]
    ds_read_b64_tr_b16 v[186:187], v6 offset:9216
    v_mfma_f32_16x16x32_bf16 v[52:55], v[132:135], v[152:155], v[52:55]
    ds_read_b128 v[172:175], v3 offset:6144
    v_mfma_f32_16x16x32_bf16 v[56:59], v[136:139], v[152:155], v[56:59]
    ds_read_b64_tr_b16 v[188:189], v7 offset:8192
    v_mfma_f32_16x16x32_bf16 v[60:63], v[140:143], v[152:155], v[60:63]
    ds_read_b64_tr_b16 v[190:191], v7 offset:9216
    v_mfma_f32_16x16x32_bf16 v[236:239], v[128:131], v[156:159], v[236:239]
    v_mfma_f32_16x16x32_bf16 v[240:243], v[132:135], v[156:159], v[240:243]
    v_mfma_f32_16x16x32_bf16 v[244:247], v[136:139], v[156:159], v[244:247]
    v_mfma_f32_16x16x32_bf16 v[248:251], v[140:143], v[156:159], v[248:251]
    s_waitcnt lgkmcnt(0)
    s_barrier
    v_mfma_f32_16x16x32_bf16 v[16:19], v[160:163], v[176:179], v[16:19]
    ds_read_b128 v[128:131], v2 offset:32768
    v_mfma_f32_16x16x32_bf16 v[20:23], v[164:167], v[176:179], v[20:23]
    ds_read_b64_tr_b16 v[144:145], v4 offset:32768
    v_mfma_f32_16x16x32_bf16 v[24:27], v[168:171], v[176:179], v[24:27]
    ds_read_b64_tr_b16 v[146:147], v4 offset:33792
    v_mfma_f32_16x16x32_bf16 v[28:31], v[172:175], v[176:179], v[28:31]
    ds_read_b128 v[132:135], v2 offset:34816
    v_mfma_f32_16x16x32_bf16 v[32:35], v[160:163], v[180:183], v[32:35]
    ds_read_b64_tr_b16 v[148:149], v5 offset:32768
    v_mfma_f32_16x16x32_bf16 v[36:39], v[164:167], v[180:183], v[36:39]
    ds_read_b64_tr_b16 v[150:151], v5 offset:33792
    v_mfma_f32_16x16x32_bf16 v[40:43], v[168:171], v[180:183], v[40:43]
    ds_read_b128 v[136:139], v2 offset:36864
    v_mfma_f32_16x16x32_bf16 v[44:47], v[172:175], v[180:183], v[44:47]
    ds_read_b64_tr_b16 v[152:153], v6 offset:32768
    v_mfma_f32_16x16x32_bf16 v[48:51], v[160:163], v[184:187], v[48:51]
    ds_read_b64_tr_b16 v[154:155], v6 offset:33792
    v_mfma_f32_16x16x32_bf16 v[52:55], v[164:167], v[184:187], v[52:55]
    ds_read_b128 v[140:143], v2 offset:38912
    v_mfma_f32_16x16x32_bf16 v[56:59], v[168:171], v[184:187], v[56:59]
    ds_read_b64_tr_b16 v[156:157], v7 offset:32768
    v_mfma_f32_16x16x32_bf16 v[60:63], v[172:175], v[184:187], v[60:63]
    ds_read_b64_tr_b16 v[158:159], v7 offset:33792
    v_mfma_f32_16x16x32_bf16 v[236:239], v[160:163], v[188:191], v[236:239]
    v_mfma_f32_16x16x32_bf16 v[240:243], v[164:167], v[188:191], v[240:243]
    v_mfma_f32_16x16x32_bf16 v[244:247], v[168:171], v[188:191], v[244:247]
    v_mfma_f32_16x16x32_bf16 v[248:251], v[172:175], v[188:191], v[248:251]
    s_waitcnt lgkmcnt(0)
    v_mfma_f32_16x16x32_bf16 v[16:19], v[128:131], v[144:147], v[16:19]
    ds_read_b128 v[160:163], v3 offset:32768
    v_mfma_f32_16x16x32_bf16 v[20:23], v[132:135], v[144:147], v[20:23]
    ds_read_b64_tr_b16 v[176:177], v4 offset:40960
    v_mfma_f32_16x16x32_bf16 v[24:27], v[136:139], v[144:147], v[24:27]
    ds_read_b64_tr_b16 v[178:179], v4 offset:41984
    v_mfma_f32_16x16x32_bf16 v[28:31], v[140:143], v[144:147], v[28:31]
    ds_read_b128 v[164:167], v3 offset:34816
    v_mfma_f32_16x16x32_bf16 v[32:35], v[128:131], v[148:151], v[32:35]
    ds_read_b64_tr_b16 v[180:181], v5 offset:40960
    v_mfma_f32_16x16x32_bf16 v[36:39], v[132:135], v[148:151], v[36:39]
    ds_read_b64_tr_b16 v[182:183], v5 offset:41984
    v_mfma_f32_16x16x32_bf16 v[40:43], v[136:139], v[148:151], v[40:43]
    ds_read_b128 v[168:171], v3 offset:36864
    v_mfma_f32_16x16x32_bf16 v[44:47], v[140:143], v[148:151], v[44:47]
    ds_read_b64_tr_b16 v[184:185], v6 offset:40960
    v_mfma_f32_16x16x32_bf16 v[48:51], v[128:131], v[152:155], v[48:51]
    ds_read_b64_tr_b16 v[186:187], v6 offset:41984
    v_mfma_f32_16x16x32_bf16 v[52:55], v[132:135], v[152:155], v[52:55]
    ds_read_b128 v[172:175], v3 offset:38912
    v_mfma_f32_16x16x32_bf16 v[56:59], v[136:139], v[152:155], v[56:59]
    ds_read_b64_tr_b16 v[188:189], v7 offset:40960
    v_mfma_f32_16x16x32_bf16 v[60:63], v[140:143], v[152:155], v[60:63]
    ds_read_b64_tr_b16 v[190:191], v7 offset:41984
    v_mfma_f32_16x16x32_bf16 v[236:239], v[128:131], v[156:159], v[236:239]
    v_mfma_f32_16x16x32_bf16 v[240:243], v[132:135], v[156:159], v[240:243]
    v_mfma_f32_16x16x32_bf16 v[244:247], v[136:139], v[156:159], v[244:247]
    v_mfma_f32_16x16x32_bf16 v[248:251], v[140:143], v[156:159], v[248:251]
    s_waitcnt lgkmcnt(0)
    s_barrier
    v_mfma_f32_16x16x32_bf16 v[16:19], v[160:163], v[176:179], v[16:19]
    v_xor_b32 v2, 0x10000, v2
    v_xor_b32 v3, 0x10000, v3
    v_mfma_f32_16x16x32_bf16 v[20:23], v[164:167], v[176:179], v[20:23]
    v_xor_b32 v4, 0x10000, v4
    v_xor_b32 v5, 0x10000, v5
    v_mfma_f32_16x16x32_bf16 v[24:27], v[168:171], v[176:179], v[24:27]
    v_xor_b32 v6, 0x10000, v6
    v_xor_b32 v7, 0x10000, v7
    v_mfma_f32_16x16x32_bf16 v[28:31], v[172:175], v[176:179], v[28:31]
    ds_read_b128 v[128:131], v2 offset:0
    v_mfma_f32_16x16x32_bf16 v[32:35], v[160:163], v[180:183], v[32:35]
    ds_read_b64_tr_b16 v[144:145], v4 offset:0
    v_mfma_f32_16x16x32_bf16 v[36:39], v[164:167], v[180:183], v[36:39]
    ds_read_b64_tr_b16 v[146:147], v4 offset:1024
    v_mfma_f32_16x16x32_bf16 v[40:43], v[168:171], v[180:183], v[40:43]
    ds_read_b128 v[132:135], v2 offset:2048
    v_mfma_f32_16x16x32_bf16 v[44:47], v[172:175], v[180:183], v[44:47]
    ds_read_b64_tr_b16 v[148:149], v5 offset:0
    v_mfma_f32_16x16x32_bf16 v[48:51], v[160:163], v[184:187], v[48:51]
    ds_read_b64_tr_b16 v[150:151], v5 offset:1024
    v_mfma_f32_16x16x32_bf16 v[52:55], v[164:167], v[184:187], v[52:55]
    ds_read_b128 v[136:139], v2 offset:4096
    v_mfma_f32_16x16x32_bf16 v[56:59], v[168:171], v[184:187], v[56:59]
    ds_read_b64_tr_b16 v[152:153], v6 offset:0
    v_mfma_f32_16x16x32_bf16 v[60:63], v[172:175], v[184:187], v[60:63]
    ds_read_b64_tr_b16 v[154:155], v6 offset:1024
    v_mfma_f32_16x16x32_bf16 v[236:239], v[160:163], v[188:191], v[236:239]
    ds_read_b128 v[140:143], v2 offset:6144
    v_mfma_f32_16x16x32_bf16 v[240:243], v[164:167], v[188:191], v[240:243]
    ds_read_b64_tr_b16 v[156:157], v7 offset:0
    v_mfma_f32_16x16x32_bf16 v[244:247], v[168:171], v[188:191], v[244:247]
    ds_read_b64_tr_b16 v[158:159], v7 offset:1024
    v_mfma_f32_16x16x32_bf16 v[248:251], v[172:175], v[188:191], v[248:251]
    s_sub_u32 s58, s58, 1
    s_cmp_lg_u32 s58, 0
    s_cbranch_scc1 LA_loopV
    s_mov_b32 s79, 1
    s_cmp_lg_u32 s94, 0
    s_cbranch_scc1 LA_round2
    s_waitcnt lgkmcnt(0)
    v_mfma_f32_16x16x32_bf16 v[16:19], v[128:131], v[144:147], v[16:19]
    ds_read_b128 v[160:163], v3 offset:0
    v_mfma_f32_16x16x32_bf16 v[20:23], v[132:135], v[144:147], v[20:23]
    ds_read_b64_tr_b16 v[176:177], v4 offset:8192
    v_mfma_f32_16x16x32_bf16 v[24:27], v[136:139], v[144:147], v[24:27]
    ds_read_b64_tr_b16 v[178:179], v4 offset:9216
    v_mfma_f32_16x16x32_bf16 v[28:31], v[140:143], v[144:147], v[28:31]
    ds_read_b128 v[164:167], v3 offset:2048
    v_mfma_f32_16x16x32_bf16 v[32:35], v[128:131], v[148:151], v[32:35]
    ds_read_b64_tr_b16 v[180:181], v5 offset:8192
    v_mfma_f32_16x16x32_bf16 v[36:39], v[132:135], v[148:151], v[36:39]
    ds_read_b64_tr_b16 v[182:183], v5 offset:9216
    v_mfma_f32_16x16x32_bf16 v[40:43], v[136:139], v[148:151], v[40:43]
    ds_read_b128 v[168:171], v3 offset:4096
    v_mfma_f32_16x16x32_bf16 v[44:47], v[140:143], v[148:151], v[44:47]
    ds_read_b64_tr_b16 v[184:185], v6 offset:8192
    v_mfma_f32_16x16x32_bf16 v[48:51], v[128:131], v[152:155], v[48:51]
    ds_read_b64_tr_b16 v[186:187], v6 offset:9216
    v_mfma_f32_16x16x32_bf16 v[52:55], v[132:135], v[152:155], v[52:55]
    ds_read_b128 v[172:175], v3 offset:6144
    v_mfma_f32_16x16x32_bf16 v[56:59], v[136:139], v[152:155], v[56:59]
    ds_read_b64_tr_b16 v[188:189], v7 offset:8192
    v_mfma_f32_16x16x32_bf16 v[60:63], v[140:143], v[152:155], v[60:63]
    ds_read_b64_tr_b16 v[190:191], v7 offset:9216
    v_mfma_f32_16x16x32_bf16 v[236:239], v[128:131], v[156:159], v[236:239]
    v_mfma_f32_16x16x32_bf16 v[240:243], v[132:135], v[156:159], v[240:243]
    v_mfma_f32_16x16x32_bf16 v[244:247], v[136:139], v[156:159], v[244:247]
    v_mfma_f32_16x16x32_bf16 v[248:251], v[140:143], v[156:159], v[248:251]
    s_waitcnt lgkmcnt(0)
    s_barrier
    v_mfma_f32_16x16x32_bf16 v[16:19], v[160:163], v[176:179], v[16:19]
    ds_read_b128 v[128:131], v2 offset:32768
    v_mfma_f32_16x16x32_bf16 v[20:23], v[164:167], v[176:179], v[20:23]
    ds_read_b64_tr_b16 v[144:145], v4 offset:32768
    v_mfma_f32_16x16x32_bf16 v[24:27], v[168:171], v[176:179], v[24:27]
    ds_read_b64_tr_b16 v[146:147], v4 offset:33792
    v_mfma_f32_16x16x32_bf16 v[28:31], v[172:175], v[176:179], v[28:31]
    ds_read_b128 v[132:135], v2 offset:34816
    v_mfma_f32_16x16x32_bf16 v[32:35], v[160:163], v[180:183], v[32:35]
    ds_read_b64_tr_b16 v[148:149], v5 offset:32768
    v_mfma_f32_16x16x32_bf16 v[36:39], v[164:167], v[180:183], v[36:39]
    ds_read_b64_tr_b16 v[150:151], v5 offset:33792
    v_mfma_f32_16x16x32_bf16 v[40:43], v[168:171], v[180:183], v[40:43]
    ds_read_b128 v[136:139], v2 offset:36864
    v_mfma_f32_16x16x32_bf16 v[44:47], v[172:175], v[180:183], v[44:47]
    ds_read_b64_tr_b16 v[152:153], v6 offset:32768
    v_mfma_f32_16x16x32_bf16 v[48:51], v[160:163], v[184:187], v[48:51]
    ds_read_b64_tr_b16 v[154:155], v6 offset:33792
    v_mfma_f32_16x16x32_bf16 v[52:55], v[164:167], v[184:187], v[52:55]
    ds_read_b128 v[140:143], v2 offset:38912
    v_mfma_f32_16x16x32_bf16 v[56:59], v[168:171], v[184:187], v[56:59]
    ds_read_b64_tr_b16 v[156:157], v7 offset:32768
    v_mfma_f32_16x16x32_bf16 v[60:63], v[172:175], v[184:187], v[60:63]
    ds_read_b64_tr_b16 v[158:159], v7 offset:33792
    v_mfma_f32_16x16x32_bf16 v[236:239], v[160:163], v[188:191], v[236:239]
    v_mfma_f32_16x16x32_bf16 v[240:243], v[164:167], v[188:191], v[240:243]
    v_mfma_f32_16x16x32_bf16 v[244:247], v[168:171], v[188:191], v[244:247]
    v_mfma_f32_16x16x32_bf16 v[248:251], v[172:175], v[188:191], v[248:251]
    s_waitcnt lgkmcnt(0)
    v_mfma_f32_16x16x32_bf16 v[16:19], v[128:131], v[144:147], v[16:19]
    ds_read_b128 v[160:163], v3 offset:32768
    v_mfma_f32_16x16x32_bf16 v[20:23], v[132:135], v[144:147], v[20:23]
    ds_read_b64_tr_b16 v[176:177], v4 offset:40960
    v_mfma_f32_16x16x32_bf16 v[24:27], v[136:139], v[144:147], v[24:27]
    ds_read_b64_tr_b16 v[178:179], v4 offset:41984
    v_mfma_f32_16x16x32_bf16 v[28:31], v[140:143], v[144:147], v[28:31]
    ds_read_b128 v[164:167], v3 offset:34816
    v_mfma_f32_16x16x32_bf16 v[32:35], v[128:131], v[148:151], v[32:35]
    ds_read_b64_tr_b16 v[180:181], v5 offset:40960
    v_mfma_f32_16x16x32_bf16 v[36:39], v[132:135], v[148:151], v[36:39]
    ds_read_b64_tr_b16 v[182:183], v5 offset:41984
    v_mfma_f32_16x16x32_bf16 v[40:43], v[136:139], v[148:151], v[40:43]
    ds_read_b128 v[168:171], v3 offset:36864
    v_mfma_f32_16x16x32_bf16 v[44:47], v[140:143], v[148:151], v[44:47]
    ds_read_b64_tr_b16 v[184:185], v6 offset:40960
    v_mfma_f32_16x16x32_bf16 v[48:51], v[128:131], v[152:155], v[48:51]
    ds_read_b64_tr_b16 v[186:187], v6 offset:41984
    v_mfma_f32_16x16x32_bf16 v[52:55], v[132:135], v[152:155], v[52:55]
    ds_read_b128 v[172:175], v3 offset:38912
    v_mfma_f32_16x16x32_bf16 v[56:59], v[136:139], v[152:155], v[56:59]
    ds_read_b64_tr_b16 v[188:189], v7 offset:40960
    v_mfma_f32_16x16x32_bf16 v[60:63], v[140:143], v[152:155], v[60:63]
    ds_read_b64_tr_b16 v[190:191], v7 offset:41984
    v_mfma_f32_16x16x32_bf16 v[236:239], v[128:131], v[156:159], v[236:239]
    v_mfma_f32_16x16x32_bf16 v[240:243], v[132:135], v[156:159], v[240:243]
    v_mfma_f32_16x16x32_bf16 v[244:247], v[136:139], v[156:159], v[244:247]
    v_mfma_f32_16x16x32_bf16 v[248:251], v[140:143], v[156:159], v[248:251]
    s_waitcnt lgkmcnt(0)
    v_mfma_f32_16x16x32_bf16 v[16:19], v[160:163], v[176:179], v[16:19]
    v_mfma_f32_16x16x32_bf16 v[20:23], v[164:167], v[176:179], v[20:23]
    v_mfma_f32_16x16x32_bf16 v[24:27], v[168:171], v[176:179], v[24:27]
    v_mfma_f32_16x16x32_bf16 v[28:31], v[172:175], v[176:179], v[28:31]
    v_mfma_f32_16x16x32_bf16 v[32:35], v[160:163], v[180:183], v[32:35]
    v_mfma_f32_16x16x32_bf16 v[36:39], v[164:167], v[180:183], v[36:39]
    v_mfma_f32_16x16x32_bf16 v[40:43], v[168:171], v[180:183], v[40:43]
    v_mfma_f32_16x16x32_bf16 v[44:47], v[172:175], v[180:183], v[44:47]
    v_mfma_f32_16x16x32_bf16 v[48:51], v[160:163], v[184:187], v[48:51]
    v_mfma_f32_16x16x32_bf16 v[52:55], v[164:167], v[184:187], v[52:55]
    v_mfma_f32_16x16x32_bf16 v[56:59], v[168:171], v[184:187], v[56:59]
    v_mfma_f32_16x16x32_bf16 v[60:63], v[172:175], v[184:187], v[60:63]
    v_mfma_f32_16x16x32_bf16 v[236:239], v[160:163], v[188:191], v[236:239]
    v_mfma_f32_16x16x32_bf16 v[240:243], v[164:167], v[188:191], v[240:243]
    v_mfma_f32_16x16x32_bf16 v[244:247], v[168:171], v[188:191], v[244:247]
    v_mfma_f32_16x16x32_bf16 v[248:251], v[172:175], v[188:191], v[248:251]
LA_sepi:
    s_nop 7
    v_pk_mul_f32 v[16:17], v[16:17], s[66:67]
    v_pk_mul_f32 v[18:19], v[18:19], s[66:67]
    v_pk_mul_f32 v[20:21], v[20:21], s[66:67]
    v_pk_mul_f32 v[22:23], v[22:23], s[66:67]
    v_cvt_pk_bf16_f32 v216, v16, v17
    v_cvt_pk_bf16_f32 v217, v18, v19
    v_cvt_pk_bf16_f32 v218, v20, v21
    v_cvt_pk_bf16_f32 v219, v22, v23
    buffer_store_dwordx4 v[216:219], v208, s[12:15], s70 offen sc1
    v_pk_mul_f32 v[24:25], v[24:25], s[66:67]
    v_pk_mul_f32 v[26:27], v[26:27], s[66:67]
    v_pk_mul_f32 v[28:29], v[28:29], s[66:67]
    v_pk_mul_f32 v[30:31], v[30:31], s[66:67]
    v_cvt_pk_bf16_f32 v220, v24, v25
    v_cvt_pk_bf16_f32 v221, v26, v27
    v_cvt_pk_bf16_f32 v222, v28, v29
    v_cvt_pk_bf16_f32 v223, v30, v31
    buffer_store_dwordx4 v[220:223], v209, s[12:15], s70 offen sc1
    v_pk_mul_f32 v[32:33], v[32:33], s[66:67]
    v_pk_mul_f32 v[34:35], v[34:35], s[66:67]
    v_pk_mul_f32 v[36:37], v[36:37], s[66:67]
    v_pk_mul_f32 v[38:39], v[38:39], s[66:67]
    v_cvt_pk_bf16_f32 v224, v32, v33
    v_cvt_pk_bf16_f32 v225, v34, v35
    v_cvt_pk_bf16_f32 v226, v36, v37
    v_cvt_pk_bf16_f32 v227, v38, v39
    buffer_store_dwordx4 v[224:227], v210, s[12:15], s70 offen sc1
    v_pk_mul_f32 v[40:41], v[40:41], s[66:67]
    v_pk_mul_f32 v[42:43], v[42:43], s[66:67]
    v_pk_mul_f32 v[44:45], v[44:45], s[66:67]
    v_pk_mul_f32 v[46:47], v[46:47], s[66:67]
    v_cvt_pk_bf16_f32 v228, v40, v41
    v_cvt_pk_bf16_f32 v229, v42, v43
    v_cvt_pk_bf16_f32 v230, v44, v45
    v_cvt_pk_bf16_f32 v231, v46, v47
    buffer_store_dwordx4 v[228:231], v211, s[12:15], s70 offen sc1
    v_pk_mul_f32 v[48:49], v[48:49], s[66:67]
    v_pk_mul_f32 v[50:51], v[50:51], s[66:67]
    v_pk_mul_f32 v[52:53], v[52:53], s[66:67]
    v_pk_mul_f32 v[54:55], v[54:55], s[66:67]
    v_cvt_pk_bf16_f32 v216, v48, v49
    v_cvt_pk_bf16_f32 v217, v50, v51
    v_cvt_pk_bf16_f32 v218, v52, v53
    v_cvt_pk_bf16_f32 v219, v54, v55
    buffer_store_dwordx4 v[216:219], v212, s[12:15], s70 offen sc1
    v_pk_mul_f32 v[56:57], v[56:57], s[66:67]
    v_pk_mul_f32 v[58:59], v[58:59], s[66:67]
    v_pk_mul_f32 v[60:61], v[60:61], s[66:67]
    v_pk_mul_f32 v[62:63], v[62:63], s[66:67]
    v_cvt_pk_bf16_f32 v220, v56, v57
    v_cvt_pk_bf16_f32 v221, v58, v59
    v_cvt_pk_bf16_f32 v222, v60, v61
    v_cvt_pk_bf16_f32 v223, v62, v63
    buffer_store_dwordx4 v[220:223], v213, s[12:15], s70 offen sc1
    v_pk_mul_f32 v[236:237], v[236:237], s[66:67]
    v_pk_mul_f32 v[238:239], v[238:239], s[66:67]
    v_pk_mul_f32 v[240:241], v[240:241], s[66:67]
    v_pk_mul_f32 v[242:243], v[242:243], s[66:67]
    v_cvt_pk_bf16_f32 v224, v236, v237
    v_cvt_pk_bf16_f32 v225, v238, v239
    v_cvt_pk_bf16_f32 v226, v240, v241
    v_cvt_pk_bf16_f32 v227, v242, v243
    buffer_store_dwordx4 v[224:227], v214, s[12:15], s70 offen sc1
    v_pk_mul_f32 v[244:245], v[244:245], s[66:67]
    v_pk_mul_f32 v[246:247], v[246:247], s[66:67]
    v_pk_mul_f32 v[248:249], v[248:249], s[66:67]
    v_pk_mul_f32 v[250:251], v[250:251], s[66:67]
    v_cvt_pk_bf16_f32 v228, v244, v245
    v_cvt_pk_bf16_f32 v229, v246, v247
    v_cvt_pk_bf16_f32 v230, v248, v249
    v_cvt_pk_bf16_f32 v231, v250, v251
    buffer_store_dwordx4 v[228:231], v215, s[12:15], s70 offen sc1
    s_waitcnt vmcnt(0)
    s_mov_b32 s58, 0x20000
    s_branch LA_ep1_c
LA_ep1:
    buffer_load_dwordx2 v[234:235], v15, s[24:27], 0 offen sc1
    s_waitcnt vmcnt(0)
LA_ep1_c:
    v_readfirstlane_b32 s62, v234
    s_nop 0
    s_cmp_lg_u32 s62, 0
    s_cbranch_scc1 LA_ep1_ok
    s_sleep 2
    s_sub_u32 s58, s58, 1
    s_cmp_lg_u32 s58, 0
    s_cbranch_scc1 LA_ep1
LA_ep1_ok:
    buffer_store_dwordx2 v[234:235], v232, s[12:15], s78 offen sc1
    s_branch LA_short
LA_round2:
    s_waitcnt lgkmcnt(0)
    v_mfma_f32_16x16x32_bf16 v[64:67], v[144:147], v[128:131], v[192:195]
    ds_read_b128 v[160:163], v3 offset:0
    ds_read_b64_tr_b16 v[176:177], v4 offset:8192
    ds_read_b64_tr_b16 v[178:179], v4 offset:9216
    v_mfma_f32_16x16x32_bf16 v[68:71], v[144:147], v[132:135], v[192:195]
    ds_read_b128 v[164:167], v3 offset:2048
    ds_read_b64_tr_b16 v[180:181], v5 offset:8192
    v_mfma_f32_16x16x32_bf16 v[72:75], v[144:147], v[136:139], v[192:195]
    ds_read_b64_tr_b16 v[182:183], v5 offset:9216
    ds_read_b128 v[168:171], v3 offset:4096
    ds_read_b64_tr_b16 v[184:185], v6 offset:8192
    v_mfma_f32_16x16x32_bf16 v[76:79], v[144:147], v[140:143], v[192:195]
    ds_read_b64_tr_b16 v[186:187], v6 offset:9216
    ds_read_b128 v[172:175], v3 offset:6144
    v_mfma_f32_16x16x32_bf16 v[80:83], v[148:151], v[128:131], v[196:199]
    ds_read_b64_tr_b16 v[188:189], v7 offset:8192
    ds_read_b64_tr_b16 v[190:191], v7 offset:9216
    v_pk_mul_f32 v[16:17], v[16:17], s[66:67]
    v_mfma_f32_16x16x32_bf16 v[84:87], v[148:151], v[132:135], v[196:199]
    v_pk_mul_f32 v[18:19], v[18:19], s[66:67]
    v_pk_mul_f32 v[20:21], v[20:21], s[66:67]
    v_mfma_f32_16x16x32_bf16 v[88:91], v[148:151], v[136:139], v[196:199]
    v_pk_mul_f32 v[22:23], v[22:23], s[66:67]
    v_cvt_pk_bf16_f32 v216, v16, v17
    v_cvt_pk_bf16_f32 v217, v18, v19
    v_mfma_f32_16x16x32_bf16 v[92:95], v[148:151], v[140:143], v[196:199]
    v_cvt_pk_bf16_f32 v218, v20, v21
    v_cvt_pk_bf16_f32 v219, v22, v23
    v_mfma_f32_16x16x32_bf16 v[96:99], v[152:155], v[128:131], v[200:203]
    buffer_store_dwordx4 v[216:219], v208, s[12:15], s70 offen sc1
    v_pk_mul_f32 v[24:25], v[24:25], s[66:67]
    v_mfma_f32_16x16x32_bf16 v[100:103], v[152:155], v[132:135], v[200:203]
    v_pk_mul_f32 v[26:27], v[26:27], s[66:67]
    v_pk_mul_f32 v[28:29], v[28:29], s[66:67]
    v_pk_mul_f32 v[30:31], v[30:31], s[66:67]
    v_mfma_f32_16x16x32_bf16 v[104:107], v[152:155], v[136:139], v[200:203]
    v_cvt_pk_bf16_f32 v220, v24, v25
    v_cvt_pk_bf16_f32 v221, v26, v27
    v_mfma_f32_16x16x32_bf16 v[108:111], v[152:155], v[140:143], v[200:203]
    v_cvt_pk_bf16_f32 v222, v28, v29
    v_cvt_pk_bf16_f32 v223, v30, v31
    buffer_store_dwordx4 v[220:223], v209, s[12:15], s70 offen sc1
    v_mfma_f32_16x16x32_bf16 v[112:115], v[156:159], v[128:131], v[204:207]
    v_pk_mul_f32 v[32:33], v[32:33], s[66:67]
    v_pk_mul_f32 v[34:35], v[34:35], s[66:67]
    v_mfma_f32_16x16x32_bf16 v[116:119], v[156:159], v[132:135], v[204:207]
    v_pk_mul_f32 v[36:37], v[36:37], s[66:67]
    v_pk_mul_f32 v[38:39], v[38:39], s[66:67]
    v_cvt_pk_bf16_f32 v224, v32, v33
    v_mfma_f32_16x16x32_bf16 v[120:123], v[156:159], v[136:139], v[204:207]
    v_cvt_pk_bf16_f32 v225, v34, v35
    v_cvt_pk_bf16_f32 v226, v36, v37
    v_mfma_f32_16x16x32_bf16 v[124:127], v[156:159], v[140:143], v[204:207]
    v_cvt_pk_bf16_f32 v227, v38, v39
    buffer_store_dwordx4 v[224:227], v210, s[12:15], s70 offen sc1
    s_waitcnt lgkmcnt(0)
    s_barrier
    v_mfma_f32_16x16x32_bf16 v[64:67], v[176:179], v[160:163], v[64:67]
    ds_read_b128 v[128:131], v2 offset:32768
    ds_read_b64_tr_b16 v[144:145], v4 offset:32768
    ds_read_b64_tr_b16 v[146:147], v4 offset:33792
    v_mfma_f32_16x16x32_bf16 v[68:71], v[176:179], v[164:167], v[68:71]
    ds_read_b128 v[132:135], v2 offset:34816
    ds_read_b64_tr_b16 v[148:149], v5 offset:32768
    v_mfma_f32_16x16x32_bf16 v[72:75], v[176:179], v[168:171], v[72:75]
    ds_read_b64_tr_b16 v[150:151], v5 offset:33792
    ds_read_b128 v[136:139], v2 offset:36864
    ds_read_b64_tr_b16 v[152:153], v6 offset:32768
    v_mfma_f32_16x16x32_bf16 v[76:79], v[176:179], v[172:175], v[76:79]
    ds_read_b64_tr_b16 v[154:155], v6 offset:33792
    ds_read_b128 v[140:143], v2 offset:38912
    v_mfma_f32_16x16x32_bf16 v[80:83], v[180:183], v[160:163], v[80:83]
    ds_read_b64_tr_b16 v[156:157], v7 offset:32768
    ds_read_b64_tr_b16 v[158:159], v7 offset:33792
    v_pk_mul_f32 v[40:41], v[40:41], s[66:67]
    v_mfma_f32_16x16x32_bf16 v[84:87], v[180:183], v[164:167], v[84:87]
    v_pk_mul_f32 v[42:43], v[42:43], s[66:67]
    v_pk_mul_f32 v[44:45], v[44:45], s[66:67]
    v_mfma_f32_16x16x32_bf16 v[88:91], v[180:183], v[168:171], v[88:91]
    v_pk_mul_f32 v[46:47], v[46:47], s[66:67]
    v_cvt_pk_bf16_f32 v228, v40, v41
    v_cvt_pk_bf16_f32 v229, v42, v43
    v_mfma_f32_16x16x32_bf16 v[92:95], v[180:183], v[172:175], v[92:95]
    v_cvt_pk_bf16_f32 v230, v44, v45
    v_cvt_pk_bf16_f32 v231, v46, v47
    v_mfma_f32_16x16x32_bf16 v[96:99], v[184:187], v[160:163], v[96:99]
    buffer_store_dwordx4 v[228:231], v211, s[12:15], s70 offen sc1
    v_pk_mul_f32 v[48:49], v[48:49], s[66:67]
    v_mfma_f32_16x16x32_bf16 v[100:103], v[184:187], v[164:167], v[100:103]
    v_pk_mul_f32 v[50:51], v[50:51], s[66:67]
    v_pk_mul_f32 v[52:53], v[52:53], s[66:67]
    v_pk_mul_f32 v[54:55], v[54:55], s[66:67]
    v_mfma_f32_16x16x32_bf16 v[104:107], v[184:187], v[168:171], v[104:107]
    v_cvt_pk_bf16_f32 v216, v48, v49
    v_cvt_pk_bf16_f32 v217, v50, v51
    v_mfma_f32_16x16x32_bf16 v[108:111], v[184:187], v[172:175], v[108:111]
    v_cvt_pk_bf16_f32 v218, v52, v53
    v_cvt_pk_bf16_f32 v219, v54, v55
    buffer_store_dwordx4 v[216:219], v212, s[12:15], s70 offen sc1
    v_mfma_f32_16x16x32_bf16 v[112:115], v[188:191], v[160:163], v[112:115]
    v_pk_mul_f32 v[56:57], v[56:57], s[66:67]
    v_pk_mul_f32 v[58:59], v[58:59], s[66:67]
    v_mfma_f32_16x16x32_bf16 v[116:119], v[188:191], v[164:167], v[116:119]
    v_pk_mul_f32 v[60:61], v[60:61], s[66:67]
    v_pk_mul_f32 v[62:63], v[62:63], s[66:67]
    v_cvt_pk_bf16_f32 v220, v56, v57
    v_mfma_f32_16x16x32_bf16 v[120:123], v[188:191], v[168:171], v[120:123]
    v_cvt_pk_bf16_f32 v221, v58, v59
    v_cvt_pk_bf16_f32 v222, v60, v61
    v_mfma_f32_16x16x32_bf16 v[124:127], v[188:191], v[172:175], v[124:127]
    v_cvt_pk_bf16_f32 v223, v62, v63
    buffer_store_dwordx4 v[220:223], v213, s[12:15], s70 offen sc1
    s_waitcnt lgkmcnt(0)
    v_mfma_f32_16x16x32_bf16 v[64:67], v[144:147], v[128:131], v[64:67]
    ds_read_b128 v[160:163], v3 offset:32768
    ds_read_b64_tr_b16 v[176:177], v4 offset:40960
    v_mfma_f32_16x16x32_bf16 v[68:71], v[144:147], v[132:135], v[68:71]
    ds_read_b64_tr_b16 v[178:179], v4 offset:41984
    ds_read_b128 v[164:167], v3 offset:34816
    v_mfma_f32_16x16x32_bf16 v[72:75], v[144:147], v[136:139], v[72:75]
    ds_read_b64_tr_b16 v[180:181], v5 offset:40960
    ds_read_b64_tr_b16 v[182:183], v5 offset:41984
    v_mfma_f32_16x16x32_bf16 v[76:79], v[144:147], v[140:143], v[76:79]
    ds_read_b128 v[168:171], v3 offset:36864
    ds_read_b64_tr_b16 v[184:185], v6 offset:40960
    v_mfma_f32_16x16x32_bf16 v[80:83], v[148:151], v[128:131], v[80:83]
    ds_read_b64_tr_b16 v[186:187], v6 offset:41984
    ds_read_b128 v[172:175], v3 offset:38912
    v_mfma_f32_16x16x32_bf16 v[84:87], v[148:151], v[132:135], v[84:87]
    ds_read_b64_tr_b16 v[188:189], v7 offset:40960
    ds_read_b64_tr_b16 v[190:191], v7 offset:41984
    v_mfma_f32_16x16x32_bf16 v[88:91], v[148:151], v[136:139], v[88:91]
    v_pk_mul_f32 v[236:237], v[236:237], s[66:67]
    v_pk_mul_f32 v[238:239], v[238:239], s[66:67]
    v_mfma_f32_16x16x32_bf16 v[92:95], v[148:151], v[140:143], v[92:95]
    v_pk_mul_f32 v[240:241], v[240:241], s[66:67]
    v_mfma_f32_16x16x32_bf16 v[96:99], v[152:155], v[128:131], v[96:99]
    v_pk_mul_f32 v[242:243], v[242:243], s[66:67]
    v_cvt_pk_bf16_f32 v224, v236, v237
    v_mfma_f32_16x16x32_bf16 v[100:103], v[152:155], v[132:135], v[100:103]
    v_cvt_pk_bf16_f32 v225, v238, v239
    v_cvt_pk_bf16_f32 v226, v240, v241
    v_mfma_f32_16x16x32_bf16 v[104:107], v[152:155], v[136:139], v[104:107]
    v_cvt_pk_bf16_f32 v227, v242, v243
    buffer_store_dwordx4 v[224:227], v214, s[12:15], s70 offen sc1
    v_mfma_f32_16x16x32_bf16 v[108:111], v[152:155], v[140:143], v[108:111]
    v_pk_mul_f32 v[244:245], v[244:245], s[66:67]
    v_pk_mul_f32 v[246:247], v[246:247], s[66:67]
    v_mfma_f32_16x16x32_bf16 v[112:115], v[156:159], v[128:131], v[112:115]
    v_pk_mul_f32 v[248:249], v[248:249], s[66:67]
    v_pk_mul_f32 v[250:251], v[250:251], s[66:67]
    v_mfma_f32_16x16x32_bf16 v[116:119], v[156:159], v[132:135], v[116:119]
    v_cvt_pk_bf16_f32 v228, v244, v245
    v_cvt_pk_bf16_f32 v229, v246, v247
    v_mfma_f32_16x16x32_bf16 v[120:123], v[156:159], v[136:139], v[120:123]
    v_cvt_pk_bf16_f32 v230, v248, v249
    v_cvt_pk_bf16_f32 v231, v250, v251
    v_mfma_f32_16x16x32_bf16 v[124:127], v[156:159], v[140:143], v[124:127]
    buffer_store_dwordx4 v[228:231], v215, s[12:15], s70 offen sc1
    s_waitcnt lgkmcnt(0)
    s_barrier
    v_mfma_f32_16x16x32_bf16 v[64:67], v[176:179], v[160:163], v[64:67]
    v_xor_b32 v2, 0x10000, v2
    v_xor_b32 v3, 0x10000, v3
    v_mfma_f32_16x16x32_bf16 v[68:71], v[176:179], v[164:167], v[68:71]
    v_xor_b32 v4, 0x10000, v4
    v_xor_b32 v5, 0x10000, v5
    v_mfma_f32_16x16x32_bf16 v[72:75], v[176:179], v[168:171], v[72:75]
    v_xor_b32 v6, 0x10000, v6
    v_xor_b32 v7, 0x10000, v7
    v_mfma_f32_16x16x32_bf16 v[76:79], v[176:179], v[172:175], v[76:79]
    ds_read_b128 v[128:131], v2 offset:0
    v_mfma_f32_16x16x32_bf16 v[80:83], v[180:183], v[160:163], v[80:83]
    ds_read_b64_tr_b16 v[144:145], v4 offset:0
    v_mfma_f32_16x16x32_bf16 v[84:87], v[180:183], v[164:167], v[84:87]
    ds_read_b64_tr_b16 v[146:147], v4 offset:1024
    v_mfma_f32_16x16x32_bf16 v[88:91], v[180:183], v[168:171], v[88:91]
    ds_read_b128 v[132:135], v2 offset:2048
    v_mfma_f32_16x16x32_bf16 v[92:95], v[180:183], v[172:175], v[92:95]
    ds_read_b64_tr_b16 v[148:149], v5 offset:0
    v_mfma_f32_16x16x32_bf16 v[96:99], v[184:187], v[160:163], v[96:99]
    ds_read_b64_tr_b16 v[150:151], v5 offset:1024
    v_mfma_f32_16x16x32_bf16 v[100:103], v[184:187], v[164:167], v[100:103]
    ds_read_b128 v[136:139], v2 offset:4096
    v_mfma_f32_16x16x32_bf16 v[104:107], v[184:187], v[168:171], v[104:107]
    ds_read_b64_tr_b16 v[152:153], v6 offset:0
    v_mfma_f32_16x16x32_bf16 v[108:111], v[184:187], v[172:175], v[108:111]
    ds_read_b64_tr_b16 v[154:155], v6 offset:1024
    v_mfma_f32_16x16x32_bf16 v[112:115], v[188:191], v[160:163], v[112:115]
    ds_read_b128 v[140:143], v2 offset:6144
    v_mfma_f32_16x16x32_bf16 v[116:119], v[188:191], v[164:167], v[116:119]
    ds_read_b64_tr_b16 v[156:157], v7 offset:0
    v_mfma_f32_16x16x32_bf16 v[120:123], v[188:191], v[168:171], v[120:123]
    ds_read_b64_tr_b16 v[158:159], v7 offset:1024
    v_mfma_f32_16x16x32_bf16 v[124:127], v[188:191], v[172:175], v[124:127]
    s_mov_b32 s58, 3
LA_loop2:
    s_waitcnt lgkmcnt(0)
    v_mfma_f32_16x16x32_bf16 v[64:67], v[144:147], v[128:131], v[64:67]
    ds_read_b128 v[160:163], v3 offset:0
    v_mfma_f32_16x16x32_bf16 v[68:71], v[144:147], v[132:135], v[68:71]
    ds_read_b64_tr_b16 v[176:177], v4 offset:8192
    v_mfma_f32_16x16x32_bf16 v[72:75], v[144:147], v[136:139], v[72:75]
    ds_read_b64_tr_b16 v[178:179], v4 offset:9216
    v_mfma_f32_16x16x32_bf16 v[76:79], v[144:147], v[140:143], v[76:79]
    ds_read_b128 v[164:167], v3 offset:2048
    v_mfma_f32_16x16x32_bf16 v[80:83], v[148:151], v[128:131], v[80:83]
    ds_read_b64_tr_b16 v[180:181], v5 offset:8192
    v_mfma_f32_16x16x32_bf16 v[84:87], v[148:151], v[132:135], v[84:87]
    ds_read_b64_tr_b16 v[182:183], v5 offset:9216
    v_mfma_f32_16x16x32_bf16 v[88:91], v[148:151], v[136:139], v[88:91]
    ds_read_b128 v[168:171], v3 offset:4096
    v_mfma_f32_16x16x32_bf16 v[92:95], v[148:151], v[140:143], v[92:95]
    ds_read_b64_tr_b16 v[184:185], v6 offset:8192
    v_mfma_f32_16x16x32_bf16 v[96:99], v[152:155], v[128:131], v[96:99]
    ds_read_b64_tr_b16 v[186:187], v6 offset:9216
    v_mfma_f32_16x16x32_bf16 v[100:103], v[152:155], v[132:135], v[100:103]
    ds_read_b128 v[172:175], v3 offset:6144
    v_mfma_f32_16x16x32_bf16 v[104:107], v[152:155], v[136:139], v[104:107]
    ds_read_b64_tr_b16 v[188:189], v7 offset:8192
    v_mfma_f32_16x16x32_bf16 v[108:111], v[152:155], v[140:143], v[108:111]
    ds_read_b64_tr_b16 v[190:191], v7 offset:9216
    v_mfma_f32_16x16x32_bf16 v[112:115], v[156:159], v[128:131], v[112:115]
    v_mfma_f32_16x16x32_bf16 v[116:119], v[156:159], v[132:135], v[116:119]
    v_mfma_f32_16x16x32_bf16 v[120:123], v[156:159], v[136:139], v[120:123]
    v_mfma_f32_16x16x32_bf16 v[124:127], v[156:159], v[140:143], v[124:127]
    s_waitcnt lgkmcnt(0)
    s_barrier
    v_mfma_f32_16x16x32_bf16 v[64:67], v[176:179], v[160:163], v[64:67]
    ds_read_b128 v[128:131], v2 offset:32768
    v_mfma_f32_16x16x32_bf16 v[68:71], v[176:179], v[164:167], v[68:71]
    ds_read_b64_tr_b16 v[144:145], v4 offset:32768
    v_mfma_f32_16x16x32_bf16 v[72:75], v[176:179], v[168:171], v[72:75]
    ds_read_b64_tr_b16 v[146:147], v4 offset:33792
    v_mfma_f32_16x16x32_bf16 v[76:79], v[176:179], v[172:175], v[76:79]
    ds_read_b128 v[132:135], v2 offset:34816
    v_mfma_f32_16x16x32_bf16 v[80:83], v[180:183], v[160:163], v[80:83]
    ds_read_b64_tr_b16 v[148:149], v5 offset:32768
    v_mfma_f32_16x16x32_bf16 v[84:87], v[180:183], v[164:167], v[84:87]
    ds_read_b64_tr_b16 v[150:151], v5 offset:33792
    v_mfma_f32_16x16x32_bf16 v[88:91], v[180:183], v[168:171], v[88:91]
    ds_read_b128 v[136:139], v2 offset:36864
    v_mfma_f32_16x16x32_bf16 v[92:95], v[180:183], v[172:175], v[92:95]
    ds_read_b64_tr_b16 v[152:153], v6 offset:32768
    v_mfma_f32_16x16x32_bf16 v[96:99], v[184:187], v[160:163], v[96:99]
    ds_read_b64_tr_b16 v[154:155], v6 offset:33792
    v_mfma_f32_16x16x32_bf16 v[100:103], v[184:187], v[164:167], v[100:103]
    ds_read_b128 v[140:143], v2 offset:38912
    v_mfma_f32_16x16x32_bf16 v[104:107], v[184:187], v[168:171], v[104:107]
    ds_read_b64_tr_b16 v[156:157], v7 offset:32768
    v_mfma_f32_16x16x32_bf16 v[108:111], v[184:187], v[172:175], v[108:111]
    ds_read_b64_tr_b16 v[158:159], v7 offset:33792
    v_mfma_f32_16x16x32_bf16 v[112:115], v[188:191], v[160:163], v[112:115]
    s_cmp_lg_u32 s79, 0
    v_mfma_f32_16x16x32_bf16 v[116:119], v[188:191], v[164:167], v[116:119]
    s_cbranch_scc1 LA_flag
LA_flagd:
    v_mfma_f32_16x16x32_bf16 v[120:123], v[188:191], v[168:171], v[120:123]
    v_mfma_f32_16x16x32_bf16 v[124:127], v[188:191], v[172:175], v[124:127]
    s_waitcnt lgkmcnt(0)
    v_mfma_f32_16x16x32_bf16 v[64:67], v[144:147], v[128:131], v[64:67]
    ds_read_b128 v[160:163], v3 offset:32768
    v_mfma_f32_16x16x32_bf16 v[68:71], v[144:147], v[132:135], v[68:71]
    ds_read_b64_tr_b16 v[176:177], v4 offset:40960
    v_mfma_f32_16x16x32_bf16 v[72:75], v[144:147], v[136:139], v[72:75]
    ds_read_b64_tr_b16 v[178:179], v4 offset:41984
    v_mfma_f32_16x16x32_bf16 v[76:79], v[144:147], v[140:143], v[76:79]
    ds_read_b128 v[164:167], v3 offset:34816
    v_mfma_f32_16x16x32_bf16 v[80:83], v[148:151], v[128:131], v[80:83]
    ds_read_b64_tr_b16 v[180:181], v5 offset:40960
    v_mfma_f32_16x16x32_bf16 v[84:87], v[148:151], v[132:135], v[84:87]
    ds_read_b64_tr_b16 v[182:183], v5 offset:41984
    v_mfma_f32_16x16x32_bf16 v[88:91], v[148:151], v[136:139], v[88:91]
    ds_read_b128 v[168:171], v3 offset:36864
    v_mfma_f32_16x16x32_bf16 v[92:95], v[148:151], v[140:143], v[92:95]
    ds_read_b64_tr_b16 v[184:185], v6 offset:40960
    v_mfma_f32_16x16x32_bf16 v[96:99], v[152:155], v[128:131], v[96:99]
    ds_read_b64_tr_b16 v[186:187], v6 offset:41984
    v_mfma_f32_16x16x32_bf16 v[100:103], v[152:155], v[132:135], v[100:103]
    ds_read_b128 v[172:175], v3 offset:38912
    v_mfma_f32_16x16x32_bf16 v[104:107], v[152:155], v[136:139], v[104:107]
    ds_read_b64_tr_b16 v[188:189], v7 offset:40960
    v_mfma_f32_16x16x32_bf16 v[108:111], v[152:155], v[140:143], v[108:111]
    ds_read_b64_tr_b16 v[190:191], v7 offset:41984
    v_mfma_f32_16x16x32_bf16 v[112:115], v[156:159], v[128:131], v[112:115]
    v_mfma_f32_16x16x32_bf16 v[116:119], v[156:159], v[132:135], v[116:119]
    v_mfma_f32_16x16x32_bf16 v[120:123], v[156:159], v[136:139], v[120:123]
    v_mfma_f32_16x16x32_bf16 v[124:127], v[156:159], v[140:143], v[124:127]
    s_waitcnt lgkmcnt(0)
    s_barrier
    v_mfma_f32_16x16x32_bf16 v[64:67], v[176:179], v[160:163], v[64:67]
    v_xor_b32 v2, 0x10000, v2
    v_xor_b32 v3, 0x10000, v3
    v_mfma_f32_16x16x32_bf16 v[68:71], v[176:179], v[164:167], v[68:71]
    v_xor_b32 v4, 0x10000, v4
    v_xor_b32 v5, 0x10000, v5
    v_mfma_f32_16x16x32_bf16 v[72:75], v[176:179], v[168:171], v[72:75]
    v_xor_b32 v6, 0x10000, v6
    v_xor_b32 v7, 0x10000, v7
    v_mfma_f32_16x16x32_bf16 v[76:79], v[176:179], v[172:175], v[76:79]
    ds_read_b128 v[128:131], v2 offset:0
    v_mfma_f32_16x16x32_bf16 v[80:83], v[180:183], v[160:163], v[80:83]
    ds_read_b64_tr_b16 v[144:145], v4 offset:0
    v_mfma_f32_16x16x32_bf16 v[84:87], v[180:183], v[164:167], v[84:87]
    ds_read_b64_tr_b16 v[146:147], v4 offset:1024
    v_mfma_f32_16x16x32_bf16 v[88:91], v[180:183], v[168:171], v[88:91]
    ds_read_b128 v[132:135], v2 offset:2048
    v_mfma_f32_16x16x32_bf16 v[92:95], v[180:183], v[172:175], v[92:95]
    ds_read_b64_tr_b16 v[148:149], v5 offset:0
    v_mfma_f32_16x16x32_bf16 v[96:99], v[184:187], v[160:163], v[96:99]
    ds_read_b64_tr_b16 v[150:151], v5 offset:1024
    v_mfma_f32_16x16x32_bf16 v[100:103], v[184:187], v[164:167], v[100:103]
    ds_read_b128 v[136:139], v2 offset:4096
    v_mfma_f32_16x16x32_bf16 v[104:107], v[184:187], v[168:171], v[104:107]
    ds_read_b64_tr_b16 v[152:153], v6 offset:0
    v_mfma_f32_16x16x32_bf16 v[108:111], v[184:187], v[172:175], v[108:111]
    ds_read_b64_tr_b16 v[154:155], v6 offset:1024
    v_mfma_f32_16x16x32_bf16 v[112:115], v[188:191], v[160:163], v[112:115]
    ds_read_b128 v[140:143], v2 offset:6144
    v_mfma_f32_16x16x32_bf16 v[116:119], v[188:191], v[164:167], v[116:119]
    ds_read_b64_tr_b16 v[156:157], v7 offset:0
    v_mfma_f32_16x16x32_bf16 v[120:123], v[188:191], v[168:171], v[120:123]
    ds_read_b64_tr_b16 v[158:159], v7 offset:1024
    v_mfma_f32_16x16x32_bf16 v[124:127], v[188:191], v[172:175], v[124:127]
    s_sub_u32 s58, s58, 1
    s_cmp_lg_u32 s58, 0
    s_cbranch_scc1 LA_loop2
    s_waitcnt lgkmcnt(0)
    v_mfma_f32_16x16x32_bf16 v[64:67], v[144:147], v[128:131], v[64:67]
    ds_read_b128 v[160:163], v3 offset:0
    v_mfma_f32_16x16x32_bf16 v[68:71], v[144:147], v[132:135], v[68:71]
    ds_read_b64_tr_b16 v[176:177], v4 offset:8192
    v_mfma_f32_16x16x32_bf16 v[72:75], v[144:147], v[136:139], v[72:75]
    ds_read_b64_tr_b16 v[178:179], v4 offset:9216
    v_mfma_f32_16x16x32_bf16 v[76:79], v[144:147], v[140:143], v[76:79]
    ds_read_b128 v[164:167], v3 offset:2048
    v_mfma_f32_16x16x32_bf16 v[80:83], v[148:151], v[128:131], v[80:83]
    ds_read_b64_tr_b16 v[180:181], v5 offset:8192
    v_mfma_f32_16x16x32_bf16 v[84:87], v[148:151], v[132:135], v[84:87]
    ds_read_b64_tr_b16 v[182:183], v5 offset:9216
    v_mfma_f32_16x16x32_bf16 v[88:91], v[148:151], v[136:139], v[88:91]
    ds_read_b128 v[168:171], v3 offset:4096
    v_mfma_f32_16x16x32_bf16 v[92:95], v[148:151], v[140:143], v[92:95]
    ds_read_b64_tr_b16 v[184:185], v6 offset:8192
    v_mfma_f32_16x16x32_bf16 v[96:99], v[152:155], v[128:131], v[96:99]
    ds_read_b64_tr_b16 v[186:187], v6 offset:9216
    v_mfma_f32_16x16x32_bf16 v[100:103], v[152:155], v[132:135], v[100:103]
    ds_read_b128 v[172:175], v3 offset:6144
    v_mfma_f32_16x16x32_bf16 v[104:107], v[152:155], v[136:139], v[104:107]
    ds_read_b64_tr_b16 v[188:189], v7 offset:8192
    v_mfma_f32_16x16x32_bf16 v[108:111], v[152:155], v[140:143], v[108:111]
    ds_read_b64_tr_b16 v[190:191], v7 offset:9216
    v_mfma_f32_16x16x32_bf16 v[112:115], v[156:159], v[128:131], v[112:115]
    v_mfma_f32_16x16x32_bf16 v[116:119], v[156:159], v[132:135], v[116:119]
    v_mfma_f32_16x16x32_bf16 v[120:123], v[156:159], v[136:139], v[120:123]
    v_mfma_f32_16x16x32_bf16 v[124:127], v[156:159], v[140:143], v[124:127]
    s_waitcnt lgkmcnt(0)
    s_barrier
    v_mfma_f32_16x16x32_bf16 v[64:67], v[176:179], v[160:163], v[64:67]
    ds_read_b128 v[128:131], v2 offset:32768
    v_mfma_f32_16x16x32_bf16 v[68:71], v[176:179], v[164:167], v[68:71]
    ds_read_b64_tr_b16 v[144:145], v4 offset:32768
    v_mfma_f32_16x16x32_bf16 v[72:75], v[176:179], v[168:171], v[72:75]
    ds_read_b64_tr_b16 v[146:147], v4 offset:33792
    v_mfma_f32_16x16x32_bf16 v[76:79], v[176:179], v[172:175], v[76:79]
    ds_read_b128 v[132:135], v2 offset:34816
    v_mfma_f32_16x16x32_bf16 v[80:83], v[180:183], v[160:163], v[80:83]
    ds_read_b64_tr_b16 v[148:149], v5 offset:32768
    v_mfma_f32_16x16x32_bf16 v[84:87], v[180:183], v[164:167], v[84:87]
    ds_read_b64_tr_b16 v[150:151], v5 offset:33792
    v_mfma_f32_16x16x32_bf16 v[88:91], v[180:183], v[168:171], v[88:91]
    ds_read_b128 v[136:139], v2 offset:36864
    v_mfma_f32_16x16x32_bf16 v[92:95], v[180:183], v[172:175], v[92:95]
    ds_read_b64_tr_b16 v[152:153], v6 offset:32768
    v_mfma_f32_16x16x32_bf16 v[96:99], v[184:187], v[160:163], v[96:99]
    ds_read_b64_tr_b16 v[154:155], v6 offset:33792
    v_mfma_f32_16x16x32_bf16 v[100:103], v[184:187], v[164:167], v[100:103]
    ds_read_b128 v[140:143], v2 offset:38912
    v_mfma_f32_16x16x32_bf16 v[104:107], v[184:187], v[168:171], v[104:107]
    ds_read_b64_tr_b16 v[156:157], v7 offset:32768
    v_mfma_f32_16x16x32_bf16 v[108:111], v[184:187], v[172:175], v[108:111]
    ds_read_b64_tr_b16 v[158:159], v7 offset:33792
    v_mfma_f32_16x16x32_bf16 v[112:115], v[188:191], v[160:163], v[112:115]
    v_mfma_f32_16x16x32_bf16 v[116:119], v[188:191], v[164:167], v[116:119]
    v_mfma_f32_16x16x32_bf16 v[120:123], v[188:191], v[168:171], v[120:123]
    v_mfma_f32_16x16x32_bf16 v[124:127], v[188:191], v[172:175], v[124:127]
    s_waitcnt lgkmcnt(0)
    v_mfma_f32_16x16x32_bf16 v[64:67], v[144:147], v[128:131], v[64:67]
    ds_read_b128 v[160:163], v3 offset:32768
    ds_read_b64_tr_b16 v[176:177], v4 offset:40960
    v_mfma_f32_16x16x32_bf16 v[68:71], v[144:147], v[132:135], v[68:71]
    ds_read_b64_tr_b16 v[178:179], v4 offset:41984
    v_mfma_f32_16x16x32_bf16 v[72:75], v[144:147], v[136:139], v[72:75]
    ds_read_b128 v[164:167], v3 offset:34816
    ds_read_b64_tr_b16 v[180:181], v5 offset:40960
    v_mfma_f32_16x16x32_bf16 v[76:79], v[144:147], v[140:143], v[76:79]
    ds_read_b64_tr_b16 v[182:183], v5 offset:41984
    v_mfma_f32_16x16x32_bf16 v[80:83], v[148:151], v[128:131], v[80:83]
    ds_read_b128 v[168:171], v3 offset:36864
    v_mfma_f32_16x16x32_bf16 v[84:87], v[148:151], v[132:135], v[84:87]
    ds_read_b64_tr_b16 v[184:185], v6 offset:40960
    ds_read_b64_tr_b16 v[186:187], v6 offset:41984
    v_mfma_f32_16x16x32_bf16 v[88:91], v[148:151], v[136:139], v[88:91]
    ds_read_b128 v[172:175], v3 offset:38912
    v_mfma_f32_16x16x32_bf16 v[92:95], v[148:151], v[140:143], v[92:95]
    ds_read_b64_tr_b16 v[188:189], v7 offset:40960
    v_mfma_f32_16x16x32_bf16 v[96:99], v[152:155], v[128:131], v[96:99]
    ds_read_b64_tr_b16 v[190:191], v7 offset:41984
    buffer_load_dwordx2 v[16:17], v12, s[12:15], s85 offen offset:0 sc1
    v_mfma_f32_16x16x32_bf16 v[100:103], v[152:155], v[132:135], v[100:103]
    buffer_load_dwordx2 v[18:19], v12, s[12:15], s82 offen offset:0 sc1
    v_mfma_f32_16x16x32_bf16 v[104:107], v[152:155], v[136:139], v[104:107]
    buffer_load_dwordx2 v[20:21], v12, s[12:15], s85 offen offset:256 sc1
    buffer_load_dwordx2 v[22:23], v12, s[12:15], s82 offen offset:256 sc1
    v_mfma_f32_16x16x32_bf16 v[108:111], v[152:155], v[140:143], v[108:111]
    buffer_load_dwordx2 v[24:25], v13, s[12:15], s83 offen sc1
    v_mfma_f32_16x16x32_bf16 v[112:115], v[156:159], v[128:131], v[112:115]
    buffer_load_dwordx2 v[28:29], v10, s[12:15], s86 offen sc1
    v_mfma_f32_16x16x32_bf16 v[116:119], v[156:159], v[132:135], v[116:119]
    s_add_u32 s63, s86, 0x4000
    buffer_load_dwordx2 v[30:31], v10, s[12:15], s63 offen sc1
    v_mfma_f32_16x16x32_bf16 v[120:123], v[156:159], v[136:139], v[120:123]
    s_add_u32 s63, s86, 0x10000
    v_mfma_f32_16x16x32_bf16 v[124:127], v[156:159], v[140:143], v[124:127]
    buffer_load_dwordx2 v[38:39], v11, s[12:15], s63 offen sc1
    s_waitcnt lgkmcnt(0)
    v_mfma_f32_16x16x32_bf16 v[64:67], v[176:179], v[160:163], v[64:67]
    v_mfma_f32_16x16x32_bf16 v[68:71], v[176:179], v[164:167], v[68:71]
    v_mfma_f32_16x16x32_bf16 v[72:75], v[176:179], v[168:171], v[72:75]
    v_mfma_f32_16x16x32_bf16 v[76:79], v[176:179], v[172:175], v[76:79]
    v_mfma_f32_16x16x32_bf16 v[80:83], v[180:183], v[160:163], v[80:83]
    v_mfma_f32_16x16x32_bf16 v[84:87], v[180:183], v[164:167], v[84:87]
    v_mfma_f32_16x16x32_bf16 v[88:91], v[180:183], v[168:171], v[88:91]
    v_mfma_f32_16x16x32_bf16 v[92:95], v[180:183], v[172:175], v[92:95]
    v_mfma_f32_16x16x32_bf16 v[96:99], v[184:187], v[160:163], v[96:99]
    v_mfma_f32_16x16x32_bf16 v[100:103], v[184:187], v[164:167], v[100:103]
    v_mfma_f32_16x16x32_bf16 v[104:107], v[184:187], v[168:171], v[104:107]
    v_mfma_f32_16x16x32_bf16 v[108:111], v[184:187], v[172:175], v[108:111]
    v_mfma_f32_16x16x32_bf16 v[112:115], v[188:191], v[160:163], v[112:115]
    v_mfma_f32_16x16x32_bf16 v[116:119], v[188:191], v[164:167], v[116:119]
    v_mfma_f32_16x16x32_bf16 v[120:123], v[188:191], v[168:171], v[120:123]
    v_mfma_f32_16x16x32_bf16 v[124:127], v[188:191], v[172:175], v[124:127]
    s_nop 6
    v_max_f32 v224, 0, v64
    v_max_f32 v225, 0, v65
    v_max_f32 v226, 0, v66
    v_max_f32 v227, 0, v67
    v_max_f32 v228, 0, v80
    v_max_f32 v229, 0, v81
    v_max_f32 v230, 0, v82
    v_max_f32 v231, 0, v83
    v_pk_mul_f32 v[224:225], v[224:225], v[224:225]
    v_pk_mul_f32 v[226:227], v[226:227], v[226:227]
    v_pk_mul_f32 v[228:229], v[228:229], v[228:229]
    v_pk_mul_f32 v[230:231], v[230:231], v[230:231]
    v_cvt_pk_bf16_f32 v216, v224, v225
    v_cvt_pk_bf16_f32 v217, v226, v227
    v_cvt_pk_bf16_f32 v218, v228, v229
    v_cvt_pk_bf16_f32 v219, v230, v231
    ds_write_b128 v8, v[216:219] offset:0
    v_max_f32 v224, 0, v96
    v_max_f32 v225, 0, v97
    v_max_f32 v226, 0, v98
    v_max_f32 v227, 0, v99
    v_max_f32 v228, 0, v112
    v_max_f32 v229, 0, v113
    v_max_f32 v230, 0, v114
    v_max_f32 v231, 0, v115
    v_pk_mul_f32 v[224:225], v[224:225], v[224:225]
    v_pk_mul_f32 v[226:227], v[226:227], v[226:227]
    v_pk_mul_f32 v[228:229], v[228:229], v[228:229]
    v_pk_mul_f32 v[230:231], v[230:231], v[230:231]
    v_cvt_pk_bf16_f32 v220, v224, v225
    v_cvt_pk_bf16_f32 v221, v226, v227
    v_cvt_pk_bf16_f32 v222, v228, v229
    v_cvt_pk_bf16_f32 v223, v230, v231
    ds_write_b128 v8, v[220:223] offset:1024
    v_max_f32 v224, 0, v68
    v_max_f32 v225, 0, v69
    v_max_f32 v226, 0, v70
    v_max_f32 v227, 0, v71
    v_max_f32 v228, 0, v84
    v_max_f32 v229, 0, v85
    v_max_f32 v230, 0, v86
    v_max_f32 v231, 0, v87
    v_pk_mul_f32 v[224:225], v[224:225], v[224:225]
    v_pk_mul_f32 v[226:227], v[226:227], v[226:227]
    v_pk_mul_f32 v[228:229], v[228:229], v[228:229]
    v_pk_mul_f32 v[230:231], v[230:231], v[230:231]
    v_cvt_pk_bf16_f32 v216, v224, v225
    v_cvt_pk_bf16_f32 v217, v226, v227
    v_cvt_pk_bf16_f32 v218, v228, v229
    v_cvt_pk_bf16_f32 v219, v230, v231
    ds_write_b128 v8, v[216:219] offset:2048
    v_max_f32 v224, 0, v100
    v_max_f32 v225, 0, v101
    v_max_f32 v226, 0, v102
    v_max_f32 v227, 0, v103
    v_max_f32 v228, 0, v116
    v_max_f32 v229, 0, v117
    v_max_f32 v230, 0, v118
    v_max_f32 v231, 0, v119
    v_pk_mul_f32 v[224:225], v[224:225], v[224:225]
    v_pk_mul_f32 v[226:227], v[226:227], v[226:227]
    v_pk_mul_f32 v[228:229], v[228:229], v[228:229]
    v_pk_mul_f32 v[230:231], v[230:231], v[230:231]
    v_cvt_pk_bf16_f32 v220, v224, v225
    v_cvt_pk_bf16_f32 v221, v226, v227
    v_cvt_pk_bf16_f32 v222, v228, v229
    v_cvt_pk_bf16_f32 v223, v230, v231
    ds_write_b128 v8, v[220:223] offset:3072
    v_max_f32 v224, 0, v72
    v_max_f32 v225, 0, v73
    v_max_f32 v226, 0, v74
    v_max_f32 v227, 0, v75
    v_max_f32 v228, 0, v88
    v_max_f32 v229, 0, v89
    v_max_f32 v230, 0, v90
    v_max_f32 v231, 0, v91
    v_pk_mul_f32 v[224:225], v[224:225], v[224:225]
    v_pk_mul_f32 v[226:227], v[226:227], v[226:227]
    v_pk_mul_f32 v[228:229], v[228:229], v[228:229]
    v_pk_mul_f32 v[230:231], v[230:231], v[230:231]
    v_cvt_pk_bf16_f32 v216, v224, v225
    v_cvt_pk_bf16_f32 v217, v226, v227
    v_cvt_pk_bf16_f32 v218, v228, v229
    v_cvt_pk_bf16_f32 v219, v230, v231
    ds_write_b128 v8, v[216:219] offset:4096
    v_max_f32 v224, 0, v104
    v_max_f32 v225, 0, v105
    v_max_f32 v226, 0, v106
    v_max_f32 v227, 0, v107
    v_max_f32 v228, 0, v120
    v_max_f32 v229, 0, v121
    v_max_f32 v230, 0, v122
    v_max_f32 v231, 0, v123
    v_pk_mul_f32 v[224:225], v[224:225], v[224:225]
    v_pk_mul_f32 v[226:227], v[226:227], v[226:227]
    v_pk_mul_f32 v[228:229], v[228:229], v[228:229]
    v_pk_mul_f32 v[230:231], v[230:231], v[230:231]
    v_cvt_pk_bf16_f32 v220, v224, v225
    v_cvt_pk_bf16_f32 v221, v226, v227
    v_cvt_pk_bf16_f32 v222, v228, v229
    v_cvt_pk_bf16_f32 v223, v230, v231
    ds_write_b128 v8, v[220:223] offset:5120
    v_max_f32 v224, 0, v76
    v_max_f32 v225, 0, v77
    v_max_f32 v226, 0, v78
    v_max_f32 v227, 0, v79
    v_max_f32 v228, 0, v92
    v_max_f32 v229, 0, v93
    v_max_f32 v230, 0, v94
    v_max_f32 v231, 0, v95
    v_pk_mul_f32 v[224:225], v[224:225], v[224:225]
    v_pk_mul_f32 v[226:227], v[226:227], v[226:227]
    v_pk_mul_f32 v[228:229], v[228:229], v[228:229]
    v_pk_mul_f32 v[230:231], v[230:231], v[230:231]
    v_cvt_pk_bf16_f32 v216, v224, v225
    v_cvt_pk_bf16_f32 v217, v226, v227
    v_cvt_pk_bf16_f32 v218, v228, v229
    v_cvt_pk_bf16_f32 v219, v230, v231
    ds_write_b128 v8, v[216:219] offset:6144
    v_max_f32 v224, 0, v108
    v_max_f32 v225, 0, v109
    v_max_f32 v226, 0, v110
    v_max_f32 v227, 0, v111
    v_max_f32 v228, 0, v124
    v_max_f32 v229, 0, v125
    v_max_f32 v230, 0, v126
    v_max_f32 v231, 0, v127
    v_pk_mul_f32 v[224:225], v[224:225], v[224:225]
    v_pk_mul_f32 v[226:227], v[226:227], v[226:227]
    v_pk_mul_f32 v[228:229], v[228:229], v[228:229]
    v_pk_mul_f32 v[230:231], v[230:231], v[230:231]
    v_cvt_pk_bf16_f32 v220, v224, v225
    v_cvt_pk_bf16_f32 v221, v226, v227
    v_cvt_pk_bf16_f32 v222, v228, v229
    v_cvt_pk_bf16_f32 v223, v230, v231
    ds_write_b128 v8, v[220:223] offset:7168
    s_cmp_lg_u32 s94, 0
    s_cbranch_scc1 LA_qdone
    s_waitcnt vmcnt(0)
    s_branch LA_short
LA_flag:
    s_waitcnt vmcnt(0)
    s_mov_b32 s65, s58
    s_mov_b32 s58, 0x20000
    s_branch LA_ep_c
LA_ep:
    buffer_load_dwordx2 v[234:235], v15, s[24:27], 0 offen sc1
    s_waitcnt vmcnt(0)
LA_ep_c:
    v_readfirstlane_b32 s62, v234
    s_nop 0
    s_cmp_lg_u32 s62, 0
    s_cbranch_scc1 LA_ep_ok
    s_sleep 2
    s_sub_u32 s58, s58, 1
    s_cmp_lg_u32 s58, 0
    s_cbranch_scc1 LA_ep
LA_ep_ok:
    buffer_store_dwordx2 v[234:235], v232, s[12:15], s78 offen sc1
    s_mov_b32 s79, 0
    s_mov_b32 s58, s65
    s_branch LA_flagd
LA_short:
    s_barrier
    s_barrier
    buffer_load_dwordx2 v[234:235], v15, s[24:27], 0 offen sc1
    v_and_b32 v12, 0x3fffffff, v12
    v_and_b32 v13, 0x3fffffff, v13
    v_and_b32 v10, 0x3fffffff, v10
    v_and_b32 v11, 0x3fffffff, v11
    buffer_load_dwordx2 v[16:17], v12, s[12:15], s85 offen offset:0 sc1
    buffer_load_dwordx2 v[18:19], v12, s[12:15], s82 offen offset:0 sc1
    buffer_load_dwordx2 v[20:21], v12, s[12:15], s85 offen offset:256 sc1
    buffer_load_dwordx2 v[22:23], v12, s[12:15], s82 offen offset:256 sc1
    buffer_load_dwordx2 v[24:25], v13, s[12:15], s83 offen sc1
    buffer_load_dwordx2 v[28:29], v10, s[12:15], s86 offen sc1
    s_add_u32 s63, s86, 0x4000
    buffer_load_dwordx2 v[30:31], v10, s[12:15], s63 offen sc1
    s_add_u32 s63, s86, 0x10000
    buffer_load_dwordx2 v[38:39], v11, s[12:15], s63 offen sc1
LA_qdone:
    s_setprio 2
    v_lshrrev_b32 v1, 5, v0
    v_and_b32 v2, 0xff, v11
    v_lshl_add_u32 v2, v1, 12, v2
    v_add_u32 v3, 256, v2
    v_add_u32 v4, 8192, v11
    v_lshlrev_b32 v5, 4, v0
    v_add_u32 v5, 10240, v5
    s_mov_b32 s84, 0
    s_mov_b32 s93, 0
LA_att:
    v_mov_b64 v[168:169], 0
    v_mov_b64 v[170:171], 0
    v_mov_b64 v[172:173], 0
    v_mov_b64 v[174:175], 0
    v_mov_b64 v[176:177], 0
    v_mov_b64 v[178:179], 0
    v_mov_b64 v[180:181], 0
    v_mov_b64 v[182:183], 0
    v_mov_b64 v[184:185], 0
    v_mov_b64 v[186:187], 0
    v_mov_b64 v[188:189], 0
    v_mov_b64 v[190:191], 0
    v_mov_b64 v[192:193], 0
    v_mov_b64 v[194:195], 0
    v_mov_b64 v[196:197], 0
    v_mov_b64 v[198:199], 0
    v_mov_b64 v[164:165], 0
    v_mov_b64 v[166:167], 0
    v_mov_b64 v[52:53], 0
    v_mov_b64 v[54:55], 0
    s_and_b32 s60, s57, 1
    s_lshl_b32 s62, s96, 2
    s_add_u32 s65, s62, s52
    s_mul_i32 s62, s65, 81920
    s_lshr_b32 s63, s57, 1
    s_mul_i32 s63, s63, 1280
    s_add_u32 s62, s62, s63
    s_add_u32 s62, s62, 16941056
    s_cmp_lg_u32 s93, 0
    s_cselect_b32 s62, 0x7f000000, s62
    s_mul_i32 s63, s60, 768
    s_add_u32 s70, s63, s62
    s_lshl_b32 s64, s60, 3
    s_add_u32 s64, s64, s62
    s_add_u32 s71, s64, 512
    s_add_u32 s72, s70, 40960
    s_add_u32 s73, s71, 40960
    s_lshl_b32 s65, s65, 5
    s_add_u32 s65, s65, s57
    s_lshl_b32 s65, s65, 7
    s_add_u32 s65, s65, 19742720
    s_cmp_lg_u32 s93, 0
    s_cselect_b32 s74, 0x7f000000, s65
    v_bfe_u32 v204, v0, 4, 1
    v_mul_u32_u24 v204, 20480, v204
    v_and_b32 v205, 15, v0
    v_lshl_add_u32 v204, v205, 4, v204
    v_lshrrev_b32 v205, 5, v0
    v_lshl_add_u32 v206, v205, 8, v204
    v_lshl_add_u32 v207, v205, 30, v204
    v_mov_b32 v208, 53248
    v_mov_b32 v209, 1
    v_mov_b32 v210, 0x5f800000
    v_lshlrev_b32 v212, 30, v0
    v_lshrrev_b32 v213, 2, v0
    v_lshl_or_b32 v212, v213, 26, v212
    s_waitcnt vmcnt(0)
    v_mfma_f32_32x32x4_2b_bf16 v[88:119], v[38:39], v[24:25], 0 cbsz:1 abid:0
    s_nop 15
    s_nop 2
    v_mfma_f32_32x32x16_bf16 v[88:103], v[28:31], v[16:19], v[88:103]
    v_mfma_f32_32x32x16_bf16 v[104:119], v[28:31], v[20:23], v[104:119]
    s_nop 10
    s_cmp_lg_u32 s84, 0
    s_cbranch_scc1 LA_havemax
    v_max3_f32 v8, v88, v89, v90
    v_max_f32 v8, v8, v103
    v_max3_f32 v8, v91, v92, v8
    v_max3_f32 v8, v93, v94, v8
    v_max3_f32 v8, v95, v96, v8
    v_max3_f32 v8, v97, v98, v8
    v_max3_f32 v8, v99, v100, v8
    v_max3_f32 v8, v101, v102, v8
    v_max3_f32 v9, v104, v105, v106
    v_max_f32 v9, v9, v119
    v_max3_f32 v9, v107, v108, v9
    v_max3_f32 v9, v109, v110, v9
    v_max3_f32 v9, v111, v112, v9
    v_max3_f32 v9, v113, v114, v9
    v_max3_f32 v9, v115, v116, v9
    v_max3_f32 v9, v117, v118, v9
LA_havemax:
    v_mov_b32 v200, v8
    v_mov_b32 v201, v8
    v_mov_b32 v202, v9
    v_mov_b32 v203, v9
    s_nop 0
    v_permlane32_swap_b32 v200, v201
    v_permlane32_swap_b32 v202, v203
    s_nop 0
    v_max_f32 v200, v200, v201
    v_sub_f32 v56, 0, v200
    v_sub_f32 v57, 0, v200
    v_mov_b64 v[58:59], v[56:57]
    v_mov_b64 v[60:61], v[56:57]
    v_mov_b64 v[62:63], v[56:57]
    v_mov_b64 v[64:65], v[56:57]
    v_mov_b64 v[66:67], v[56:57]
    v_mov_b64 v[68:69], v[56:57]
    v_mov_b64 v[70:71], v[56:57]
    v_pk_add_f32 v[88:89], v[88:89], v[56:57]
    v_pk_add_f32 v[90:91], v[90:91], v[56:57]
    v_pk_add_f32 v[92:93], v[92:93], v[56:57]
    v_pk_add_f32 v[94:95], v[94:95], v[56:57]
    v_pk_add_f32 v[96:97], v[96:97], v[56:57]
    v_pk_add_f32 v[98:99], v[98:99], v[56:57]
    v_pk_add_f32 v[100:101], v[100:101], v[56:57]
    v_pk_add_f32 v[102:103], v[102:103], v[56:57]
    v_max_f32 v202, v202, v203
    v_sub_f32 v72, 0, v202
    v_sub_f32 v73, 0, v202
    v_mov_b64 v[74:75], v[72:73]
    v_mov_b64 v[76:77], v[72:73]
    v_mov_b64 v[78:79], v[72:73]
    v_mov_b64 v[80:81], v[72:73]
    v_mov_b64 v[82:83], v[72:73]
    v_mov_b64 v[84:85], v[72:73]
    v_mov_b64 v[86:87], v[72:73]
    v_pk_add_f32 v[104:105], v[104:105], v[72:73]
    v_pk_add_f32 v[106:107], v[106:107], v[72:73]
    v_pk_add_f32 v[108:109], v[108:109], v[72:73]
    v_pk_add_f32 v[110:111], v[110:111], v[72:73]
    v_pk_add_f32 v[112:113], v[112:113], v[72:73]
    v_pk_add_f32 v[114:115], v[114:115], v[72:73]
    v_pk_add_f32 v[116:117], v[116:117], v[72:73]
    v_pk_add_f32 v[118:119], v[118:119], v[72:73]
    s_waitcnt lgkmcnt(0)
    s_barrier
    ds_read2st64_b64 v[32:35], v2 offset0:0 offset1:4
    ds_read_b64 v[36:37], v4 offset:0
    ds_read_b128 v[40:43], v5 offset:0
    ds_read_b128 v[44:47], v5 offset:1024
    s_mov_b32 s58, 4
    s_mov_b32 s79, 0x7f000000
.p2align 6
LA_main:
    v_exp_f32 v88, v88
    v_exp_f32 v89, v89
    v_mfma_f32_32x32x16_bf16 v[184:199], v[52:55], v[164:167], v[184:199]
    v_exp_f32 v90, v90
    v_exp_f32 v91, v91
    v_exp_f32 v92, v92
    s_waitcnt lgkmcnt(0)
    v_mfma_f32_32x32x4_2b_bf16 v[120:151], v[36:37], v[24:25], v[56:87] cbsz:1 abid:0
    ds_read_b128 v[48:51], v5 offset:2048
    ds_read_b128 v[52:55], v5 offset:3072
    v_exp_f32 v93, v93
    v_exp_f32 v94, v94
    v_exp_f32 v95, v95
    v_cvt_pk_bf16_f32 v152, v88, v89
    v_cvt_pk_bf16_f32 v153, v90, v91
    v_cvt_pk_bf16_f32 v154, v92, v93
    v_cvt_pk_bf16_f32 v155, v94, v95
    v_exp_f32 v96, v96
    v_exp_f32 v97, v97
    v_exp_f32 v98, v98
    v_mfma_f32_32x32x16_bf16 v[168:183], v[40:43], v[152:155], v[168:183]
    v_exp_f32 v99, v99
    v_exp_f32 v100, v100
    v_exp_f32 v101, v101
    v_exp_f32 v102, v102
    v_exp_f32 v103, v103
    v_mfma_f32_32x32x16_bf16 v[120:135], v[32:35], v[16:19], v[120:135]
    v_cvt_pk_bf16_f32 v156, v96, v97
    v_cvt_pk_bf16_f32 v157, v98, v99
    v_cvt_pk_bf16_f32 v158, v100, v101
    v_cvt_pk_bf16_f32 v159, v102, v103
    v_exp_f32 v104, v104
    v_mfma_f32_32x32x16_bf16 v[136:151], v[32:35], v[20:23], v[136:151]
    ds_read2st64_b64 v[28:31], v3 offset0:0 offset1:4
    v_exp_f32 v105, v105
    v_exp_f32 v106, v106
    v_exp_f32 v107, v107
    v_mfma_f32_32x32x16_bf16 v[168:183], v[44:47], v[156:159], v[168:183]
    v_exp_f32 v108, v108
    v_exp_f32 v109, v109
    v_exp_f32 v110, v110
    v_exp_f32 v111, v111
    v_cvt_pk_bf16_f32 v160, v104, v105
    v_cvt_pk_bf16_f32 v161, v106, v107
    v_cvt_pk_bf16_f32 v162, v108, v109
    v_cvt_pk_bf16_f32 v163, v110, v111
    v_exp_f32 v112, v112
    v_exp_f32 v113, v113
    v_mfma_f32_32x32x16_bf16 v[184:199], v[40:43], v[160:163], v[184:199]
    v_exp_f32 v114, v114
    v_exp_f32 v115, v115
    v_exp_f32 v116, v116
    v_exp_f32 v117, v117
    v_cvt_pk_bf16_f32 v164, v112, v113
    v_cvt_pk_bf16_f32 v165, v114, v115
    v_exp_f32 v118, v118
    v_exp_f32 v119, v119
    v_cvt_pk_bf16_f32 v166, v116, v117
    v_cvt_pk_bf16_f32 v167, v118, v119
    v_exp_f32 v120, v120
    v_exp_f32 v121, v121
    v_mfma_f32_32x32x16_bf16 v[184:199], v[44:47], v[164:167], v[184:199]
    v_exp_f32 v122, v122
    v_exp_f32 v123, v123
    v_exp_f32 v124, v124
    s_waitcnt lgkmcnt(0)
    v_mfma_f32_32x32x4_2b_bf16 v[88:119], v[36:37], v[24:25], v[56:87] cbsz:1 abid:1
    ds_read_b128 v[40:43], v5 offset:4096
    ds_read_b128 v[44:47], v5 offset:5120
    v_exp_f32 v125, v125
    v_exp_f32 v126, v126
    v_exp_f32 v127, v127
    v_cvt_pk_bf16_f32 v152, v120, v121
    v_cvt_pk_bf16_f32 v153, v122, v123
    v_cvt_pk_bf16_f32 v154, v124, v125
    v_cvt_pk_bf16_f32 v155, v126, v127
    v_exp_f32 v128, v128
    v_exp_f32 v129, v129
    v_exp_f32 v130, v130
    v_mfma_f32_32x32x16_bf16 v[168:183], v[48:51], v[152:155], v[168:183]
    v_exp_f32 v131, v131
    v_exp_f32 v132, v132
    v_exp_f32 v133, v133
    v_exp_f32 v134, v134
    v_exp_f32 v135, v135
    v_mfma_f32_32x32x16_bf16 v[88:103], v[28:31], v[16:19], v[88:103]
    v_cvt_pk_bf16_f32 v156, v128, v129
    v_cvt_pk_bf16_f32 v157, v130, v131
    v_cvt_pk_bf16_f32 v158, v132, v133
    v_cvt_pk_bf16_f32 v159, v134, v135
    v_exp_f32 v136, v136
    v_mfma_f32_32x32x16_bf16 v[104:119], v[28:31], v[20:23], v[104:119]
    ds_read2st64_b64 v[32:35], v2 offset0:1 offset1:5
    ds_read_b64 v[38:39], v4 offset:512
    v_exp_f32 v137, v137
    v_exp_f32 v138, v138
    v_exp_f32 v139, v139
    v_mfma_f32_32x32x16_bf16 v[168:183], v[52:55], v[156:159], v[168:183]
    v_exp_f32 v140, v140
    v_exp_f32 v141, v141
    v_exp_f32 v142, v142
    v_exp_f32 v143, v143
    v_cvt_pk_bf16_f32 v160, v136, v137
    v_cvt_pk_bf16_f32 v161, v138, v139
    v_cvt_pk_bf16_f32 v162, v140, v141
    v_cvt_pk_bf16_f32 v163, v142, v143
    v_exp_f32 v144, v144
    v_exp_f32 v145, v145
    v_mfma_f32_32x32x16_bf16 v[184:199], v[48:51], v[160:163], v[184:199]
    v_exp_f32 v146, v146
    v_exp_f32 v147, v147
    v_exp_f32 v148, v148
    v_exp_f32 v149, v149
    v_cvt_pk_bf16_f32 v164, v144, v145
    v_cvt_pk_bf16_f32 v165, v146, v147
    v_exp_f32 v150, v150
    v_exp_f32 v151, v151
    v_cvt_pk_bf16_f32 v166, v148, v149
    v_cvt_pk_bf16_f32 v167, v150, v151
    v_exp_f32 v88, v88
    v_exp_f32 v89, v89
    v_mfma_f32_32x32x16_bf16 v[184:199], v[52:55], v[164:167], v[184:199]
    v_exp_f32 v90, v90
    v_exp_f32 v91, v91
    v_exp_f32 v92, v92
    s_waitcnt lgkmcnt(0)
    v_mfma_f32_32x32x4_2b_bf16 v[120:151], v[38:39], v[24:25], v[56:87] cbsz:1 abid:0
    ds_read_b128 v[48:51], v5 offset:6144
    ds_read_b128 v[52:55], v5 offset:7168
    v_exp_f32 v93, v93
    v_exp_f32 v94, v94
    v_exp_f32 v95, v95
    v_cvt_pk_bf16_f32 v152, v88, v89
    v_cvt_pk_bf16_f32 v153, v90, v91
    v_cvt_pk_bf16_f32 v154, v92, v93
    v_cvt_pk_bf16_f32 v155, v94, v95
    v_exp_f32 v96, v96
    v_exp_f32 v97, v97
    v_exp_f32 v98, v98
    v_mfma_f32_32x32x16_bf16 v[168:183], v[40:43], v[152:155], v[168:183]
    v_exp_f32 v99, v99
    v_exp_f32 v100, v100
    v_exp_f32 v101, v101
    v_exp_f32 v102, v102
    v_exp_f32 v103, v103
    v_mfma_f32_32x32x16_bf16 v[120:135], v[32:35], v[16:19], v[120:135]
    v_cvt_pk_bf16_f32 v156, v96, v97
    v_cvt_pk_bf16_f32 v157, v98, v99
    v_cvt_pk_bf16_f32 v158, v100, v101
    v_cvt_pk_bf16_f32 v159, v102, v103
    v_exp_f32 v104, v104
    v_mfma_f32_32x32x16_bf16 v[136:151], v[32:35], v[20:23], v[136:151]
    ds_read2st64_b64 v[28:31], v3 offset0:1 offset1:5
    v_exp_f32 v105, v105
    v_exp_f32 v106, v106
    v_exp_f32 v107, v107
    v_mfma_f32_32x32x16_bf16 v[168:183], v[44:47], v[156:159], v[168:183]
    v_exp_f32 v108, v108
    v_exp_f32 v109, v109
    v_exp_f32 v110, v110
    v_exp_f32 v111, v111
    v_cvt_pk_bf16_f32 v160, v104, v105
    v_cvt_pk_bf16_f32 v161, v106, v107
    v_cvt_pk_bf16_f32 v162, v108, v109
    v_cvt_pk_bf16_f32 v163, v110, v111
    v_exp_f32 v112, v112
    v_exp_f32 v113, v113
    v_mfma_f32_32x32x16_bf16 v[184:199], v[40:43], v[160:163], v[184:199]
    v_exp_f32 v114, v114
    v_exp_f32 v115, v115
    v_exp_f32 v116, v116
    v_exp_f32 v117, v117
    v_cvt_pk_bf16_f32 v164, v112, v113
    v_cvt_pk_bf16_f32 v165, v114, v115
    v_exp_f32 v118, v118
    v_exp_f32 v119, v119
    v_cvt_pk_bf16_f32 v166, v116, v117
    v_cvt_pk_bf16_f32 v167, v118, v119
    v_exp_f32 v120, v120
    v_exp_f32 v121, v121
    v_mfma_f32_32x32x16_bf16 v[184:199], v[44:47], v[164:167], v[184:199]
    v_exp_f32 v122, v122
    v_exp_f32 v123, v123
    v_exp_f32 v124, v124
    s_waitcnt lgkmcnt(0)
    v_mfma_f32_32x32x4_2b_bf16 v[88:119], v[38:39], v[24:25], v[56:87] cbsz:1 abid:1
    ds_read_b128 v[40:43], v5 offset:8192
    ds_read_b128 v[44:47], v5 offset:9216
    v_exp_f32 v125, v125
    v_exp_f32 v126, v126
    v_exp_f32 v127, v127
    v_cvt_pk_bf16_f32 v152, v120, v121
    v_cvt_pk_bf16_f32 v153, v122, v123
    v_cvt_pk_bf16_f32 v154, v124, v125
    v_cvt_pk_bf16_f32 v155, v126, v127
    v_exp_f32 v128, v128
    v_exp_f32 v129, v129
    v_exp_f32 v130, v130
    v_mfma_f32_32x32x16_bf16 v[168:183], v[48:51], v[152:155], v[168:183]
    v_exp_f32 v131, v131
    v_exp_f32 v132, v132
    v_exp_f32 v133, v133
    v_exp_f32 v134, v134
    v_exp_f32 v135, v135
    v_mfma_f32_32x32x16_bf16 v[88:103], v[28:31], v[16:19], v[88:103]
    v_cvt_pk_bf16_f32 v156, v128, v129
    v_cvt_pk_bf16_f32 v157, v130, v131
    v_cvt_pk_bf16_f32 v158, v132, v133
    v_cvt_pk_bf16_f32 v159, v134, v135
    v_exp_f32 v136, v136
    v_mfma_f32_32x32x16_bf16 v[104:119], v[28:31], v[20:23], v[104:119]
    ds_read2st64_b64 v[32:35], v2 offset0:2 offset1:6
    ds_read_b64 v[36:37], v4 offset:1024
    v_exp_f32 v137, v137
    v_exp_f32 v138, v138
    v_exp_f32 v139, v139
    v_mfma_f32_32x32x16_bf16 v[168:183], v[52:55], v[156:159], v[168:183]
    v_exp_f32 v140, v140
    v_exp_f32 v141, v141
    v_exp_f32 v142, v142
    v_exp_f32 v143, v143
    v_cvt_pk_bf16_f32 v160, v136, v137
    v_cvt_pk_bf16_f32 v161, v138, v139
    v_cvt_pk_bf16_f32 v162, v140, v141
    v_cvt_pk_bf16_f32 v163, v142, v143
    v_exp_f32 v144, v144
    v_exp_f32 v145, v145
    v_mfma_f32_32x32x16_bf16 v[184:199], v[48:51], v[160:163], v[184:199]
    v_exp_f32 v146, v146
    v_exp_f32 v147, v147
    v_exp_f32 v148, v148
    v_exp_f32 v149, v149
    v_cvt_pk_bf16_f32 v164, v144, v145
    v_cvt_pk_bf16_f32 v165, v146, v147
    v_exp_f32 v150, v150
    v_exp_f32 v151, v151
    v_cvt_pk_bf16_f32 v166, v148, v149
    v_cvt_pk_bf16_f32 v167, v150, v151
    v_exp_f32 v88, v88
    v_exp_f32 v89, v89
    v_mfma_f32_32x32x16_bf16 v[184:199], v[52:55], v[164:167], v[184:199]
    v_exp_f32 v90, v90
    v_exp_f32 v91, v91
    v_exp_f32 v92, v92
    s_waitcnt lgkmcnt(0)
    v_mfma_f32_32x32x4_2b_bf16 v[120:151], v[36:37], v[24:25], v[56:87] cbsz:1 abid:0
    ds_read_b128 v[48:51], v5 offset:10240
    ds_read_b128 v[52:55], v5 offset:11264
    v_exp_f32 v93, v93
    v_exp_f32 v94, v94
    v_exp_f32 v95, v95
    v_cvt_pk_bf16_f32 v152, v88, v89
    v_cvt_pk_bf16_f32 v153, v90, v91
    v_cvt_pk_bf16_f32 v154, v92, v93
    v_cvt_pk_bf16_f32 v155, v94, v95
    v_exp_f32 v96, v96
    v_exp_f32 v97, v97
    v_exp_f32 v98, v98
    v_mfma_f32_32x32x16_bf16 v[168:183], v[40:43], v[152:155], v[168:183]
    v_exp_f32 v99, v99
    v_exp_f32 v100, v100
    v_exp_f32 v101, v101
    v_exp_f32 v102, v102
    v_exp_f32 v103, v103
    v_mfma_f32_32x32x16_bf16 v[120:135], v[32:35], v[16:19], v[120:135]
    v_cvt_pk_bf16_f32 v156, v96, v97
    v_cvt_pk_bf16_f32 v157, v98, v99
    v_cvt_pk_bf16_f32 v158, v100, v101
    v_cvt_pk_bf16_f32 v159, v102, v103
    v_exp_f32 v104, v104
    v_mfma_f32_32x32x16_bf16 v[136:151], v[32:35], v[20:23], v[136:151]
    ds_read2st64_b64 v[28:31], v3 offset0:2 offset1:6
    v_exp_f32 v105, v105
    v_exp_f32 v106, v106
    v_exp_f32 v107, v107
    v_mfma_f32_32x32x16_bf16 v[168:183], v[44:47], v[156:159], v[168:183]
    buffer_load_dword v6, v14, s[12:15], s79 offen offset:0 sc1
    buffer_load_dword v7, v14, s[12:15], s79 offen offset:128 sc1
    v_exp_f32 v108, v108
    v_exp_f32 v109, v109
    v_exp_f32 v110, v110
    v_exp_f32 v111, v111
    v_cvt_pk_bf16_f32 v160, v104, v105
    v_cvt_pk_bf16_f32 v161, v106, v107
    v_cvt_pk_bf16_f32 v162, v108, v109
    v_cvt_pk_bf16_f32 v163, v110, v111
    v_exp_f32 v112, v112
    v_exp_f32 v113, v113
    v_mfma_f32_32x32x16_bf16 v[184:199], v[40:43], v[160:163], v[184:199]
    v_exp_f32 v114, v114
    v_exp_f32 v115, v115
    v_exp_f32 v116, v116
    v_exp_f32 v117, v117
    v_cvt_pk_bf16_f32 v164, v112, v113
    v_cvt_pk_bf16_f32 v165, v114, v115
    v_exp_f32 v118, v118
    v_exp_f32 v119, v119
    v_cvt_pk_bf16_f32 v166, v116, v117
    v_cvt_pk_bf16_f32 v167, v118, v119
    v_exp_f32 v120, v120
    v_exp_f32 v121, v121
    v_mfma_f32_32x32x16_bf16 v[184:199], v[44:47], v[164:167], v[184:199]
    v_exp_f32 v122, v122
    v_exp_f32 v123, v123
    v_exp_f32 v124, v124
    s_waitcnt lgkmcnt(0)
    v_mfma_f32_32x32x4_2b_bf16 v[88:119], v[36:37], v[24:25], v[56:87] cbsz:1 abid:1
    ds_read_b128 v[40:43], v5 offset:12288
    ds_read_b128 v[44:47], v5 offset:13312
    v_exp_f32 v125, v125
    v_exp_f32 v126, v126
    v_exp_f32 v127, v127
    v_cvt_pk_bf16_f32 v152, v120, v121
    v_cvt_pk_bf16_f32 v153, v122, v123
    v_cvt_pk_bf16_f32 v154, v124, v125
    v_cvt_pk_bf16_f32 v155, v126, v127
    v_exp_f32 v128, v128
    v_exp_f32 v129, v129
    v_exp_f32 v130, v130
    v_mfma_f32_32x32x16_bf16 v[168:183], v[48:51], v[152:155], v[168:183]
    v_exp_f32 v131, v131
    v_exp_f32 v132, v132
    v_exp_f32 v133, v133
    v_exp_f32 v134, v134
    v_exp_f32 v135, v135
    v_mfma_f32_32x32x16_bf16 v[88:103], v[28:31], v[16:19], v[88:103]
    v_cvt_pk_bf16_f32 v156, v128, v129
    v_cvt_pk_bf16_f32 v157, v130, v131
    v_cvt_pk_bf16_f32 v158, v132, v133
    v_cvt_pk_bf16_f32 v159, v134, v135
    v_exp_f32 v136, v136
    v_mfma_f32_32x32x16_bf16 v[104:119], v[28:31], v[20:23], v[104:119]
    ds_read2st64_b64 v[32:35], v2 offset0:3 offset1:7
    ds_read_b64 v[38:39], v4 offset:1536
    v_exp_f32 v137, v137
    v_exp_f32 v138, v138
    v_exp_f32 v139, v139
    v_mfma_f32_32x32x16_bf16 v[168:183], v[52:55], v[156:159], v[168:183]
    v_exp_f32 v140, v140
    v_exp_f32 v141, v141
    v_exp_f32 v142, v142
    v_exp_f32 v143, v143
    v_cvt_pk_bf16_f32 v160, v136, v137
    v_cvt_pk_bf16_f32 v161, v138, v139
    v_cvt_pk_bf16_f32 v162, v140, v141
    v_cvt_pk_bf16_f32 v163, v142, v143
    v_exp_f32 v144, v144
    v_exp_f32 v145, v145
    v_mfma_f32_32x32x16_bf16 v[184:199], v[48:51], v[160:163], v[184:199]
    v_exp_f32 v146, v146
    v_exp_f32 v147, v147
    v_exp_f32 v148, v148
    v_exp_f32 v149, v149
    v_cvt_pk_bf16_f32 v164, v144, v145
    v_cvt_pk_bf16_f32 v165, v146, v147
    v_exp_f32 v150, v150
    v_exp_f32 v151, v151
    v_cvt_pk_bf16_f32 v166, v148, v149
    v_cvt_pk_bf16_f32 v167, v150, v151
    v_exp_f32 v88, v88
    v_exp_f32 v89, v89
    v_mfma_f32_32x32x16_bf16 v[184:199], v[52:55], v[164:167], v[184:199]
    v_exp_f32 v90, v90
    v_exp_f32 v91, v91
    v_exp_f32 v92, v92
    s_waitcnt lgkmcnt(0)
    v_mfma_f32_32x32x4_2b_bf16 v[120:151], v[38:39], v[24:25], v[56:87] cbsz:1 abid:0
    ds_read_b128 v[48:51], v5 offset:14336
    ds_read_b128 v[52:55], v5 offset:15360
    v_exp_f32 v93, v93
    v_exp_f32 v94, v94
    v_exp_f32 v95, v95
    v_cvt_pk_bf16_f32 v152, v88, v89
    v_cvt_pk_bf16_f32 v153, v90, v91
    v_cvt_pk_bf16_f32 v154, v92, v93
    v_cvt_pk_bf16_f32 v155, v94, v95
    v_exp_f32 v96, v96
    v_exp_f32 v97, v97
    v_exp_f32 v98, v98
    v_mfma_f32_32x32x16_bf16 v[168:183], v[40:43], v[152:155], v[168:183]
    v_exp_f32 v99, v99
    v_exp_f32 v100, v100
    v_exp_f32 v101, v101
    v_exp_f32 v102, v102
    v_exp_f32 v103, v103
    v_mfma_f32_32x32x16_bf16 v[120:135], v[32:35], v[16:19], v[120:135]
    v_cvt_pk_bf16_f32 v156, v96, v97
    v_cvt_pk_bf16_f32 v157, v98, v99
    v_cvt_pk_bf16_f32 v158, v100, v101
    v_cvt_pk_bf16_f32 v159, v102, v103
    v_exp_f32 v104, v104
    v_mfma_f32_32x32x16_bf16 v[136:151], v[32:35], v[20:23], v[136:151]
    ds_read2st64_b64 v[28:31], v3 offset0:3 offset1:7
    v_exp_f32 v105, v105
    v_exp_f32 v106, v106
    v_exp_f32 v107, v107
    v_mfma_f32_32x32x16_bf16 v[168:183], v[44:47], v[156:159], v[168:183]
    v_exp_f32 v108, v108
    v_exp_f32 v109, v109
    v_exp_f32 v110, v110
    v_exp_f32 v111, v111
    v_cvt_pk_bf16_f32 v160, v104, v105
    v_cvt_pk_bf16_f32 v161, v106, v107
    v_cvt_pk_bf16_f32 v162, v108, v109
    v_cvt_pk_bf16_f32 v163, v110, v111
    v_exp_f32 v112, v112
    v_exp_f32 v113, v113
    v_mfma_f32_32x32x16_bf16 v[184:199], v[40:43], v[160:163], v[184:199]
    v_exp_f32 v114, v114
    v_exp_f32 v115, v115
    v_exp_f32 v116, v116
    v_exp_f32 v117, v117
    v_cvt_pk_bf16_f32 v164, v112, v113
    v_cvt_pk_bf16_f32 v165, v114, v115
    v_exp_f32 v118, v118
    v_exp_f32 v119, v119
    v_cvt_pk_bf16_f32 v166, v116, v117
    v_cvt_pk_bf16_f32 v167, v118, v119
    v_exp_f32 v120, v120
    v_exp_f32 v121, v121
    v_mfma_f32_32x32x16_bf16 v[184:199], v[44:47], v[164:167], v[184:199]
    v_exp_f32 v122, v122
    v_exp_f32 v123, v123
    v_exp_f32 v124, v124
    s_waitcnt lgkmcnt(0)
    s_barrier
    v_mfma_f32_32x32x4_2b_bf16 v[88:119], v[38:39], v[24:25], v[56:87] cbsz:1 abid:1
    ds_read_b128 v[40:43], v5 offset:26624
    ds_read_b128 v[44:47], v5 offset:27648
    v_exp_f32 v125, v125
    v_exp_f32 v126, v126
    v_exp_f32 v127, v127
    v_cvt_pk_bf16_f32 v152, v120, v121
    v_cvt_pk_bf16_f32 v153, v122, v123
    v_cvt_pk_bf16_f32 v154, v124, v125
    v_cvt_pk_bf16_f32 v155, v126, v127
    v_exp_f32 v128, v128
    v_exp_f32 v129, v129
    v_exp_f32 v130, v130
    v_mfma_f32_32x32x16_bf16 v[168:183], v[48:51], v[152:155], v[168:183]
    v_exp_f32 v131, v131
    v_exp_f32 v132, v132
    v_exp_f32 v133, v133
    v_exp_f32 v134, v134
    v_exp_f32 v135, v135
    v_mfma_f32_32x32x16_bf16 v[88:103], v[28:31], v[16:19], v[88:103]
    v_cvt_pk_bf16_f32 v156, v128, v129
    v_cvt_pk_bf16_f32 v157, v130, v131
    v_cvt_pk_bf16_f32 v158, v132, v133
    v_cvt_pk_bf16_f32 v159, v134, v135
    v_exp_f32 v136, v136
    v_mfma_f32_32x32x16_bf16 v[104:119], v[28:31], v[20:23], v[104:119]
    ds_read2st64_b64 v[32:35], v2 offset0:52 offset1:56
    ds_read_b64 v[36:37], v4 offset:26624
    v_exp_f32 v137, v137
    v_exp_f32 v138, v138
    v_exp_f32 v139, v139
    v_mfma_f32_32x32x16_bf16 v[168:183], v[52:55], v[156:159], v[168:183]
    v_exp_f32 v140, v140
    v_exp_f32 v141, v141
    v_exp_f32 v142, v142
    v_exp_f32 v143, v143
    v_cvt_pk_bf16_f32 v160, v136, v137
    v_cvt_pk_bf16_f32 v161, v138, v139
    v_cvt_pk_bf16_f32 v162, v140, v141
    v_cvt_pk_bf16_f32 v163, v142, v143
    v_exp_f32 v144, v144
    v_exp_f32 v145, v145
    v_mfma_f32_32x32x16_bf16 v[184:199], v[48:51], v[160:163], v[184:199]
    v_exp_f32 v146, v146
    v_exp_f32 v147, v147
    v_exp_f32 v148, v148
    v_exp_f32 v149, v149
    v_cvt_pk_bf16_f32 v164, v144, v145
    v_cvt_pk_bf16_f32 v165, v146, v147
    v_exp_f32 v150, v150
    v_exp_f32 v151, v151
    v_cvt_pk_bf16_f32 v166, v148, v149
    v_cvt_pk_bf16_f32 v167, v150, v151
    v_exp_f32 v88, v88
    v_exp_f32 v89, v89
    v_mfma_f32_32x32x16_bf16 v[184:199], v[52:55], v[164:167], v[184:199]
    v_exp_f32 v90, v90
    v_exp_f32 v91, v91
    v_exp_f32 v92, v92
    s_waitcnt lgkmcnt(0)
    v_mfma_f32_32x32x4_2b_bf16 v[120:151], v[36:37], v[24:25], v[56:87] cbsz:1 abid:0
    ds_read_b128 v[48:51], v5 offset:28672
    ds_read_b128 v[52:55], v5 offset:29696
    v_exp_f32 v93, v93
    v_exp_f32 v94, v94
    v_exp_f32 v95, v95
    v_cvt_pk_bf16_f32 v152, v88, v89
    v_cvt_pk_bf16_f32 v153, v90, v91
    v_cvt_pk_bf16_f32 v154, v92, v93
    v_cvt_pk_bf16_f32 v155, v94, v95
    v_exp_f32 v96, v96
    v_exp_f32 v97, v97
    v_exp_f32 v98, v98
    v_mfma_f32_32x32x16_bf16 v[168:183], v[40:43], v[152:155], v[168:183]
    v_exp_f32 v99, v99
    v_exp_f32 v100, v100
    v_exp_f32 v101, v101
    v_exp_f32 v102, v102
    v_exp_f32 v103, v103
    v_mfma_f32_32x32x16_bf16 v[120:135], v[32:35], v[16:19], v[120:135]
    v_cvt_pk_bf16_f32 v156, v96, v97
    v_cvt_pk_bf16_f32 v157, v98, v99
    v_cvt_pk_bf16_f32 v158, v100, v101
    v_cvt_pk_bf16_f32 v159, v102, v103
    v_exp_f32 v104, v104
    v_mfma_f32_32x32x16_bf16 v[136:151], v[32:35], v[20:23], v[136:151]
    ds_read2st64_b64 v[28:31], v3 offset0:52 offset1:56
    v_exp_f32 v105, v105
    v_exp_f32 v106, v106
    v_exp_f32 v107, v107
    v_mfma_f32_32x32x16_bf16 v[168:183], v[44:47], v[156:159], v[168:183]
    v_exp_f32 v108, v108
    v_exp_f32 v109, v109
    v_exp_f32 v110, v110
    v_exp_f32 v111, v111
    v_cvt_pk_bf16_f32 v160, v104, v105
    v_cvt_pk_bf16_f32 v161, v106, v107
    v_cvt_pk_bf16_f32 v162, v108, v109
    v_cvt_pk_bf16_f32 v163, v110, v111
    v_exp_f32 v112, v112
    v_exp_f32 v113, v113
    v_mfma_f32_32x32x16_bf16 v[184:199], v[40:43], v[160:163], v[184:199]
    v_exp_f32 v114, v114
    v_exp_f32 v115, v115
    v_exp_f32 v116, v116
    v_exp_f32 v117, v117
    v_cvt_pk_bf16_f32 v164, v112, v113
    v_cvt_pk_bf16_f32 v165, v114, v115
    v_exp_f32 v118, v118
    v_exp_f32 v119, v119
    v_cvt_pk_bf16_f32 v166, v116, v117
    v_cvt_pk_bf16_f32 v167, v118, v119
    v_exp_f32 v120, v120
    v_exp_f32 v121, v121
    v_mfma_f32_32x32x16_bf16 v[184:199], v[44:47], v[164:167], v[184:199]
    v_exp_f32 v122, v122
    v_exp_f32 v123, v123
    v_exp_f32 v124, v124
    s_waitcnt lgkmcnt(0)
    v_mfma_f32_32x32x4_2b_bf16 v[88:119], v[36:37], v[24:25], v[56:87] cbsz:1 abid:1
    ds_read_b128 v[40:43], v5 offset:30720
    ds_read_b128 v[44:47], v5 offset:31744
    v_exp_f32 v125, v125
    v_exp_f32 v126, v126
    v_exp_f32 v127, v127
    v_cvt_pk_bf16_f32 v152, v120, v121
    v_cvt_pk_bf16_f32 v153, v122, v123
    v_cvt_pk_bf16_f32 v154, v124, v125
    v_cvt_pk_bf16_f32 v155, v126, v127
    v_exp_f32 v128, v128
    v_exp_f32 v129, v129
    v_exp_f32 v130, v130
    v_mfma_f32_32x32x16_bf16 v[168:183], v[48:51], v[152:155], v[168:183]
    v_exp_f32 v131, v131
    v_exp_f32 v132, v132
    v_exp_f32 v133, v133
    v_exp_f32 v134, v134
    v_exp_f32 v135, v135
    v_mfma_f32_32x32x16_bf16 v[88:103], v[28:31], v[16:19], v[88:103]
    v_cvt_pk_bf16_f32 v156, v128, v129
    v_cvt_pk_bf16_f32 v157, v130, v131
    v_cvt_pk_bf16_f32 v158, v132, v133
    v_cvt_pk_bf16_f32 v159, v134, v135
    v_exp_f32 v136, v136
    v_mfma_f32_32x32x16_bf16 v[104:119], v[28:31], v[20:23], v[104:119]
    ds_read2st64_b64 v[32:35], v2 offset0:53 offset1:57
    ds_read_b64 v[38:39], v4 offset:27136
    v_exp_f32 v137, v137
    v_exp_f32 v138, v138
    v_exp_f32 v139, v139
    v_mfma_f32_32x32x16_bf16 v[168:183], v[52:55], v[156:159], v[168:183]
    v_exp_f32 v140, v140
    v_exp_f32 v141, v141
    v_exp_f32 v142, v142
    v_exp_f32 v143, v143
    v_cvt_pk_bf16_f32 v160, v136, v137
    v_cvt_pk_bf16_f32 v161, v138, v139
    v_cvt_pk_bf16_f32 v162, v140, v141
    v_cvt_pk_bf16_f32 v163, v142, v143
    v_exp_f32 v144, v144
    v_exp_f32 v145, v145
    v_mfma_f32_32x32x16_bf16 v[184:199], v[48:51], v[160:163], v[184:199]
    v_exp_f32 v146, v146
    v_exp_f32 v147, v147
    v_exp_f32 v148, v148
    v_exp_f32 v149, v149
    v_cvt_pk_bf16_f32 v164, v144, v145
    v_cvt_pk_bf16_f32 v165, v146, v147
    v_exp_f32 v150, v150
    v_exp_f32 v151, v151
    v_cvt_pk_bf16_f32 v166, v148, v149
    v_cvt_pk_bf16_f32 v167, v150, v151
    v_exp_f32 v88, v88
    v_exp_f32 v89, v89
    v_mfma_f32_32x32x16_bf16 v[184:199], v[52:55], v[164:167], v[184:199]
    v_exp_f32 v90, v90
    v_exp_f32 v91, v91
    v_exp_f32 v92, v92
    s_waitcnt lgkmcnt(0)
    v_mfma_f32_32x32x4_2b_bf16 v[120:151], v[38:39], v[24:25], v[56:87] cbsz:1 abid:0
    ds_read_b128 v[48:51], v5 offset:32768
    ds_read_b128 v[52:55], v5 offset:33792
    v_exp_f32 v93, v93
    v_exp_f32 v94, v94
    v_exp_f32 v95, v95
    v_cvt_pk_bf16_f32 v152, v88, v89
    v_cvt_pk_bf16_f32 v153, v90, v91
    v_cvt_pk_bf16_f32 v154, v92, v93
    v_cvt_pk_bf16_f32 v155, v94, v95
    v_exp_f32 v96, v96
    v_exp_f32 v97, v97
    v_exp_f32 v98, v98
    v_mfma_f32_32x32x16_bf16 v[168:183], v[40:43], v[152:155], v[168:183]
    v_exp_f32 v99, v99
    v_exp_f32 v100, v100
    v_exp_f32 v101, v101
    v_exp_f32 v102, v102
    v_exp_f32 v103, v103
    v_mfma_f32_32x32x16_bf16 v[120:135], v[32:35], v[16:19], v[120:135]
    v_cvt_pk_bf16_f32 v156, v96, v97
    v_cvt_pk_bf16_f32 v157, v98, v99
    v_cvt_pk_bf16_f32 v158, v100, v101
    v_cvt_pk_bf16_f32 v159, v102, v103
    v_exp_f32 v104, v104
    v_mfma_f32_32x32x16_bf16 v[136:151], v[32:35], v[20:23], v[136:151]
    ds_read2st64_b64 v[28:31], v3 offset0:53 offset1:57
    v_exp_f32 v105, v105
    v_exp_f32 v106, v106
    v_exp_f32 v107, v107
    v_mfma_f32_32x32x16_bf16 v[168:183], v[44:47], v[156:159], v[168:183]
    v_exp_f32 v108, v108
    v_exp_f32 v109, v109
    v_exp_f32 v110, v110
    v_exp_f32 v111, v111
    v_cvt_pk_bf16_f32 v160, v104, v105
    v_cvt_pk_bf16_f32 v161, v106, v107
    v_cvt_pk_bf16_f32 v162, v108, v109
    v_cvt_pk_bf16_f32 v163, v110, v111
    v_exp_f32 v112, v112
    v_exp_f32 v113, v113
    v_mfma_f32_32x32x16_bf16 v[184:199], v[40:43], v[160:163], v[184:199]
    v_exp_f32 v114, v114
    v_exp_f32 v115, v115
    v_exp_f32 v116, v116
    v_exp_f32 v117, v117
    v_cvt_pk_bf16_f32 v164, v112, v113
    v_cvt_pk_bf16_f32 v165, v114, v115
    v_exp_f32 v118, v118
    v_exp_f32 v119, v119
    v_cvt_pk_bf16_f32 v166, v116, v117
    v_cvt_pk_bf16_f32 v167, v118, v119
    v_exp_f32 v120, v120
    v_exp_f32 v121, v121
    v_mfma_f32_32x32x16_bf16 v[184:199], v[44:47], v[164:167], v[184:199]
    v_exp_f32 v122, v122
    v_exp_f32 v123, v123
    v_exp_f32 v124, v124
    s_waitcnt lgkmcnt(0)
    v_mfma_f32_32x32x4_2b_bf16 v[88:119], v[38:39], v[24:25], v[56:87] cbsz:1 abid:1
    ds_read_b128 v[40:43], v5 offset:34816
    ds_read_b128 v[44:47], v5 offset:35840
    v_exp_f32 v125, v125
    v_exp_f32 v126, v126
    v_exp_f32 v127, v127
    v_cvt_pk_bf16_f32 v152, v120, v121
    v_cvt_pk_bf16_f32 v153, v122, v123
    v_cvt_pk_bf16_f32 v154, v124, v125
    v_cvt_pk_bf16_f32 v155, v126, v127
    v_exp_f32 v128, v128
    v_exp_f32 v129, v129
    v_exp_f32 v130, v130
    v_mfma_f32_32x32x16_bf16 v[168:183], v[48:51], v[152:155], v[168:183]
    v_exp_f32 v131, v131
    v_exp_f32 v132, v132
    v_exp_f32 v133, v133
    v_exp_f32 v134, v134
    v_exp_f32 v135, v135
    v_mfma_f32_32x32x16_bf16 v[88:103], v[28:31], v[16:19], v[88:103]
    v_cvt_pk_bf16_f32 v156, v128, v129
    v_cvt_pk_bf16_f32 v157, v130, v131
    v_cvt_pk_bf16_f32 v158, v132, v133
    v_cvt_pk_bf16_f32 v159, v134, v135
    v_exp_f32 v136, v136
    v_mfma_f32_32x32x16_bf16 v[104:119], v[28:31], v[20:23], v[104:119]
    ds_read2st64_b64 v[32:35], v2 offset0:54 offset1:58
    ds_read_b64 v[36:37], v4 offset:27648
    v_exp_f32 v137, v137
    v_exp_f32 v138, v138
    v_exp_f32 v139, v139
    v_mfma_f32_32x32x16_bf16 v[168:183], v[52:55], v[156:159], v[168:183]
    v_exp_f32 v140, v140
    v_exp_f32 v141, v141
    v_exp_f32 v142, v142
    v_exp_f32 v143, v143
    v_cvt_pk_bf16_f32 v160, v136, v137
    v_cvt_pk_bf16_f32 v161, v138, v139
    v_cvt_pk_bf16_f32 v162, v140, v141
    v_cvt_pk_bf16_f32 v163, v142, v143
    v_exp_f32 v144, v144
    v_exp_f32 v145, v145
    v_mfma_f32_32x32x16_bf16 v[184:199], v[48:51], v[160:163], v[184:199]
    v_exp_f32 v146, v146
    v_exp_f32 v147, v147
    v_exp_f32 v148, v148
    v_exp_f32 v149, v149
    v_cvt_pk_bf16_f32 v164, v144, v145
    v_cvt_pk_bf16_f32 v165, v146, v147
    v_exp_f32 v150, v150
    v_exp_f32 v151, v151
    v_cvt_pk_bf16_f32 v166, v148, v149
    v_cvt_pk_bf16_f32 v167, v150, v151
    v_exp_f32 v88, v88
    v_exp_f32 v89, v89
    v_mfma_f32_32x32x16_bf16 v[184:199], v[52:55], v[164:167], v[184:199]
    v_exp_f32 v90, v90
    v_exp_f32 v91, v91
    v_exp_f32 v92, v92
    s_waitcnt lgkmcnt(0)
    v_mfma_f32_32x32x4_2b_bf16 v[120:151], v[36:37], v[24:25], v[56:87] cbsz:1 abid:0
    ds_read_b128 v[48:51], v5 offset:36864
    ds_read_b128 v[52:55], v5 offset:37888
    v_exp_f32 v93, v93
    v_exp_f32 v94, v94
    v_exp_f32 v95, v95
    v_cvt_pk_bf16_f32 v152, v88, v89
    v_cvt_pk_bf16_f32 v153, v90, v91
    v_cvt_pk_bf16_f32 v154, v92, v93
    v_cvt_pk_bf16_f32 v155, v94, v95
    v_exp_f32 v96, v96
    v_exp_f32 v97, v97
    v_exp_f32 v98, v98
    v_mfma_f32_32x32x16_bf16 v[168:183], v[40:43], v[152:155], v[168:183]
    v_exp_f32 v99, v99
    v_exp_f32 v100, v100
    v_exp_f32 v101, v101
    v_exp_f32 v102, v102
    v_exp_f32 v103, v103
    v_mfma_f32_32x32x16_bf16 v[120:135], v[32:35], v[16:19], v[120:135]
    v_cvt_pk_bf16_f32 v156, v96, v97
    v_cvt_pk_bf16_f32 v157, v98, v99
    v_cvt_pk_bf16_f32 v158, v100, v101
    v_cvt_pk_bf16_f32 v159, v102, v103
    v_exp_f32 v104, v104
    v_mfma_f32_32x32x16_bf16 v[136:151], v[32:35], v[20:23], v[136:151]
    ds_read2st64_b64 v[28:31], v3 offset0:54 offset1:58
    v_exp_f32 v105, v105
    v_exp_f32 v106, v106
    v_exp_f32 v107, v107
    v_mfma_f32_32x32x16_bf16 v[168:183], v[44:47], v[156:159], v[168:183]
    v_exp_f32 v108, v108
    v_exp_f32 v109, v109
    v_exp_f32 v110, v110
    v_exp_f32 v111, v111
    v_cvt_pk_bf16_f32 v160, v104, v105
    v_cvt_pk_bf16_f32 v161, v106, v107
    v_cvt_pk_bf16_f32 v162, v108, v109
    v_cvt_pk_bf16_f32 v163, v110, v111
    v_exp_f32 v112, v112
    v_exp_f32 v113, v113
    v_mfma_f32_32x32x16_bf16 v[184:199], v[40:43], v[160:163], v[184:199]
    v_exp_f32 v114, v114
    v_exp_f32 v115, v115
    v_exp_f32 v116, v116
    v_exp_f32 v117, v117
    v_cvt_pk_bf16_f32 v164, v112, v113
    v_cvt_pk_bf16_f32 v165, v114, v115
    v_exp_f32 v118, v118
    v_exp_f32 v119, v119
    v_cvt_pk_bf16_f32 v166, v116, v117
    v_cvt_pk_bf16_f32 v167, v118, v119
    v_exp_f32 v120, v120
    v_exp_f32 v121, v121
    v_mfma_f32_32x32x16_bf16 v[184:199], v[44:47], v[164:167], v[184:199]
    v_exp_f32 v122, v122
    v_exp_f32 v123, v123
    v_exp_f32 v124, v124
    s_waitcnt lgkmcnt(0)
    v_mfma_f32_32x32x4_2b_bf16 v[88:119], v[36:37], v[24:25], v[56:87] cbsz:1 abid:1
    ds_read_b128 v[40:43], v5 offset:38912
    ds_read_b128 v[44:47], v5 offset:39936
    v_exp_f32 v125, v125
    v_exp_f32 v126, v126
    v_exp_f32 v127, v127
    v_cvt_pk_bf16_f32 v152, v120, v121
    v_cvt_pk_bf16_f32 v153, v122, v123
    v_cvt_pk_bf16_f32 v154, v124, v125
    v_cvt_pk_bf16_f32 v155, v126, v127
    v_exp_f32 v128, v128
    v_exp_f32 v129, v129
    v_exp_f32 v130, v130
    v_mfma_f32_32x32x16_bf16 v[168:183], v[48:51], v[152:155], v[168:183]
    v_exp_f32 v131, v131
    v_exp_f32 v132, v132
    v_exp_f32 v133, v133
    v_exp_f32 v134, v134
    v_exp_f32 v135, v135
    v_mfma_f32_32x32x16_bf16 v[88:103], v[28:31], v[16:19], v[88:103]
    v_cvt_pk_bf16_f32 v156, v128, v129
    v_cvt_pk_bf16_f32 v157, v130, v131
    v_cvt_pk_bf16_f32 v158, v132, v133
    v_cvt_pk_bf16_f32 v159, v134, v135
    v_exp_f32 v136, v136
    v_mfma_f32_32x32x16_bf16 v[104:119], v[28:31], v[20:23], v[104:119]
    ds_read2st64_b64 v[32:35], v2 offset0:55 offset1:59
    ds_read_b64 v[38:39], v4 offset:28160
    v_exp_f32 v137, v137
    v_exp_f32 v138, v138
    v_exp_f32 v139, v139
    v_mfma_f32_32x32x16_bf16 v[168:183], v[52:55], v[156:159], v[168:183]
    v_exp_f32 v140, v140
    v_exp_f32 v141, v141
    v_exp_f32 v142, v142
    v_exp_f32 v143, v143
    v_cvt_pk_bf16_f32 v160, v136, v137
    v_cvt_pk_bf16_f32 v161, v138, v139
    v_cvt_pk_bf16_f32 v162, v140, v141
    v_cvt_pk_bf16_f32 v163, v142, v143
    v_exp_f32 v144, v144
    v_exp_f32 v145, v145
    v_mfma_f32_32x32x16_bf16 v[184:199], v[48:51], v[160:163], v[184:199]
    v_exp_f32 v146, v146
    v_exp_f32 v147, v147
    v_exp_f32 v148, v148
    v_exp_f32 v149, v149
    v_cvt_pk_bf16_f32 v164, v144, v145
    v_cvt_pk_bf16_f32 v165, v146, v147
    v_exp_f32 v150, v150
    v_exp_f32 v151, v151
    v_cvt_pk_bf16_f32 v166, v148, v149
    v_cvt_pk_bf16_f32 v167, v150, v151
    v_exp_f32 v88, v88
    v_exp_f32 v89, v89
    v_mfma_f32_32x32x16_bf16 v[184:199], v[52:55], v[164:167], v[184:199]
    v_exp_f32 v90, v90
    v_exp_f32 v91, v91
    v_exp_f32 v92, v92
    s_waitcnt lgkmcnt(0)
    v_mfma_f32_32x32x4_2b_bf16 v[120:151], v[38:39], v[24:25], v[56:87] cbsz:1 abid:0
    ds_read_b128 v[48:51], v5 offset:40960
    ds_read_b128 v[52:55], v5 offset:41984
    v_exp_f32 v93, v93
    v_exp_f32 v94, v94
    v_exp_f32 v95, v95
    v_cvt_pk_bf16_f32 v152, v88, v89
    v_cvt_pk_bf16_f32 v153, v90, v91
    v_cvt_pk_bf16_f32 v154, v92, v93
    v_cvt_pk_bf16_f32 v155, v94, v95
    v_exp_f32 v96, v96
    v_exp_f32 v97, v97
    v_exp_f32 v98, v98
    v_mfma_f32_32x32x16_bf16 v[168:183], v[40:43], v[152:155], v[168:183]
    v_exp_f32 v99, v99
    v_exp_f32 v100, v100
    v_exp_f32 v101, v101
    v_exp_f32 v102, v102
    v_exp_f32 v103, v103
    v_mfma_f32_32x32x16_bf16 v[120:135], v[32:35], v[16:19], v[120:135]
    v_cvt_pk_bf16_f32 v156, v96, v97
    v_cvt_pk_bf16_f32 v157, v98, v99
    v_cvt_pk_bf16_f32 v158, v100, v101
    v_cvt_pk_bf16_f32 v159, v102, v103
    v_exp_f32 v104, v104
    v_mfma_f32_32x32x16_bf16 v[136:151], v[32:35], v[20:23], v[136:151]
    ds_read2st64_b64 v[28:31], v3 offset0:55 offset1:59
    v_exp_f32 v105, v105
    v_exp_f32 v106, v106
    v_exp_f32 v107, v107
    v_mfma_f32_32x32x16_bf16 v[168:183], v[44:47], v[156:159], v[168:183]
    v_exp_f32 v108, v108
    v_exp_f32 v109, v109
    v_exp_f32 v110, v110
    v_exp_f32 v111, v111
    v_cvt_pk_bf16_f32 v160, v104, v105
    v_cvt_pk_bf16_f32 v161, v106, v107
    v_cvt_pk_bf16_f32 v162, v108, v109
    v_cvt_pk_bf16_f32 v163, v110, v111
    v_exp_f32 v112, v112
    v_exp_f32 v113, v113
    v_mfma_f32_32x32x16_bf16 v[184:199], v[40:43], v[160:163], v[184:199]
    v_exp_f32 v114, v114
    v_exp_f32 v115, v115
    v_exp_f32 v116, v116
    v_exp_f32 v117, v117
    v_cvt_pk_bf16_f32 v164, v112, v113
    v_cvt_pk_bf16_f32 v165, v114, v115
    v_exp_f32 v118, v118
    v_exp_f32 v119, v119
    v_cvt_pk_bf16_f32 v166, v116, v117
    v_cvt_pk_bf16_f32 v167, v118, v119
    v_exp_f32 v120, v120
    v_exp_f32 v121, v121
    v_mfma_f32_32x32x16_bf16 v[184:199], v[44:47], v[164:167], v[184:199]
    v_exp_f32 v122, v122
    v_exp_f32 v123, v123
    v_exp_f32 v124, v124
    s_waitcnt lgkmcnt(0)
    s_barrier
    v_mfma_f32_32x32x4_2b_bf16 v[88:119], v[38:39], v[24:25], v[56:87] cbsz:1 abid:1
    ds_read_b128 v[40:43], v5 offset:0
    ds_read_b128 v[44:47], v5 offset:1024
    v_exp_f32 v125, v125
    v_exp_f32 v126, v126
    v_exp_f32 v127, v127
    v_cvt_pk_bf16_f32 v152, v120, v121
    v_cvt_pk_bf16_f32 v153, v122, v123
    v_cvt_pk_bf16_f32 v154, v124, v125
    v_cvt_pk_bf16_f32 v155, v126, v127
    v_exp_f32 v128, v128
    v_exp_f32 v129, v129
    v_exp_f32 v130, v130
    v_mfma_f32_32x32x16_bf16 v[168:183], v[48:51], v[152:155], v[168:183]
    v_exp_f32 v131, v131
    v_exp_f32 v132, v132
    v_exp_f32 v133, v133
    v_exp_f32 v134, v134
    v_exp_f32 v135, v135
    v_mfma_f32_32x32x16_bf16 v[88:103], v[28:31], v[16:19], v[88:103]
    v_cvt_pk_bf16_f32 v156, v128, v129
    v_cvt_pk_bf16_f32 v157, v130, v131
    v_cvt_pk_bf16_f32 v158, v132, v133
    v_cvt_pk_bf16_f32 v159, v134, v135
    v_exp_f32 v136, v136
    v_mfma_f32_32x32x16_bf16 v[104:119], v[28:31], v[20:23], v[104:119]
    ds_read2st64_b64 v[32:35], v2 offset0:0 offset1:4
    ds_read_b64 v[36:37], v4 offset:0
    v_exp_f32 v137, v137
    v_exp_f32 v138, v138
    v_exp_f32 v139, v139
    v_mfma_f32_32x32x16_bf16 v[168:183], v[52:55], v[156:159], v[168:183]
    v_exp_f32 v140, v140
    v_exp_f32 v141, v141
    v_exp_f32 v142, v142
    v_exp_f32 v143, v143
    v_cvt_pk_bf16_f32 v160, v136, v137
    v_cvt_pk_bf16_f32 v161, v138, v139
    v_cvt_pk_bf16_f32 v162, v140, v141
    v_cvt_pk_bf16_f32 v163, v142, v143
    v_exp_f32 v144, v144
    v_exp_f32 v145, v145
    v_mfma_f32_32x32x16_bf16 v[184:199], v[48:51], v[160:163], v[184:199]
    v_exp_f32 v146, v146
    v_exp_f32 v147, v147
    v_exp_f32 v148, v148
    v_exp_f32 v149, v149
    v_cvt_pk_bf16_f32 v164, v144, v145
    v_cvt_pk_bf16_f32 v165, v146, v147
    v_exp_f32 v150, v150
    v_exp_f32 v151, v151
    v_cvt_pk_bf16_f32 v166, v148, v149
    v_cvt_pk_bf16_f32 v167, v150, v151
    s_sub_u32 s58, s58, 1
    s_cmp_eq_u32 s58, 1
    s_cselect_b32 s79, s91, s79
    s_cmp_lg_u32 s58, 0
    s_cbranch_scc1 LA_main
    s_nop 1
    v_mfma_f32_32x32x16_bf16 v[184:199], v[52:55], v[164:167], v[184:199]
    v_mov_b32 v88, v176
    v_mov_b32 v89, v176
    v_mov_b32 v8, 0
    s_waitcnt vmcnt(0) lgkmcnt(0)
    v_permlane32_swap_b32 v88, v89
    s_nop 1
    v_rcp_f32 v88, v89
    s_nop 0
    v_mul_f32 v92, v88, v6
    v_mul_f32 v93, v88, v6
    v_pk_mul_f32 v[96:97], v[168:169], v[92:93]
    v_pk_mul_f32 v[98:99], v[170:171], v[92:93]
    v_pk_mul_f32 v[100:101], v[172:173], v[92:93]
    v_pk_mul_f32 v[102:103], v[174:175], v[92:93]
    v_pk_mul_f32 v[104:105], v[176:177], v[92:93]
    v_pk_mul_f32 v[106:107], v[178:179], v[92:93]
    v_cvt_pk_bf16_f32 v120, v96, v97
    v_cvt_pk_bf16_f32 v121, v98, v99
    v_cvt_pk_bf16_f32 v122, v100, v101
    v_cvt_pk_bf16_f32 v123, v102, v103
    v_cvt_pk_bf16_f32 v124, v104, v105
    v_cvt_pk_bf16_f32 v125, v106, v107
    buffer_store_dwordx4 v[120:123], v206, s[12:15], s70 offen sc1
    buffer_store_dwordx2 v[124:125], v207, s[12:15], s71 offen sc1
    v_mov_b32 v90, v192
    v_mov_b32 v91, v192
    s_nop 1
    v_permlane32_swap_b32 v90, v91
    s_nop 1
    v_rcp_f32 v90, v91
    v_max_f32 v9, v89, v91
    v_mul_f32 v94, v90, v7
    v_mul_f32 v95, v90, v7
    v_pk_mul_f32 v[108:109], v[184:185], v[94:95]
    v_pk_mul_f32 v[110:111], v[186:187], v[94:95]
    v_pk_mul_f32 v[112:113], v[188:189], v[94:95]
    v_pk_mul_f32 v[114:115], v[190:191], v[94:95]
    v_pk_mul_f32 v[116:117], v[192:193], v[94:95]
    v_pk_mul_f32 v[118:119], v[194:195], v[94:95]
    v_cvt_pk_bf16_f32 v128, v108, v109
    v_cvt_pk_bf16_f32 v129, v110, v111
    v_cvt_pk_bf16_f32 v130, v112, v113
    v_cvt_pk_bf16_f32 v131, v114, v115
    v_cvt_pk_bf16_f32 v132, v116, v117
    v_cvt_pk_bf16_f32 v133, v118, v119
    buffer_store_dwordx4 v[128:131], v206, s[12:15], s72 offen sc1
    buffer_store_dwordx2 v[132:133], v207, s[12:15], s73 offen sc1
    v_fmac_f32 v8, 0, v168
    v_fmac_f32 v8, 0, v169
    v_fmac_f32 v8, 0, v170
    v_fmac_f32 v8, 0, v171
    v_fmac_f32 v8, 0, v172
    v_fmac_f32 v8, 0, v173
    v_fmac_f32 v8, 0, v174
    v_fmac_f32 v8, 0, v175
    v_fmac_f32 v8, 0, v176
    v_fmac_f32 v8, 0, v177
    v_fmac_f32 v8, 0, v178
    v_fmac_f32 v8, 0, v179
    v_fmac_f32 v8, 0, v89
    v_fmac_f32 v8, 0, v184
    v_fmac_f32 v8, 0, v185
    v_fmac_f32 v8, 0, v186
    v_fmac_f32 v8, 0, v187
    v_fmac_f32 v8, 0, v188
    v_fmac_f32 v8, 0, v189
    v_fmac_f32 v8, 0, v190
    v_fmac_f32 v8, 0, v191
    v_fmac_f32 v8, 0, v192
    v_fmac_f32 v8, 0, v193
    v_fmac_f32 v8, 0, v194
    v_fmac_f32 v8, 0, v195
    v_fmac_f32 v8, 0, v91
    v_add_f32 v8, v8, v9
    v_cmp_nlt_f32 vcc, v8, v210
    s_cmp_lg_u32 s84, 0
    s_cbranch_scc1 LA_safe
    s_cbranch_vccz LA_safe
    ds_write_b32 v208, v209
    s_mov_b32 s74, 0x7f000000
    s_waitcnt lgkmcnt(0)
    s_branch LA_bx
LA_safe:
    s_mov_b32 s93, 1
LA_bx:
    s_barrier
    ds_read_b32 v209, v208
    s_waitcnt vmcnt(0)
    buffer_store_dwordx2 v[234:235], v212, s[12:15], s74 offen sc1
    s_waitcnt lgkmcnt(0)
    v_readfirstlane_b32 s60, v209
    s_nop 1
    s_cmp_gt_u32 s60, s84
    s_cbranch_scc1 LA_fallback
    s_endpgm
LA_fallback:
    s_waitcnt vmcnt(0)
    s_mov_b32 s84, 1
    v_mov_b32 v8, 0xff800000
    v_mov_b32 v9, 0xff800000
    s_mov_b32 s62, s86
    s_mov_b32 s58, 64
LA_maxloop:
    buffer_load_dwordx2 v[28:29], v10, s[12:15], s62 offen sc1
    s_add_u32 s63, s62, 0x4000
    buffer_load_dwordx2 v[30:31], v10, s[12:15], s63 offen sc1
    s_add_u32 s63, s62, 0x10000
    buffer_load_dwordx2 v[38:39], v11, s[12:15], s63 offen sc1
    s_waitcnt vmcnt(0)
    v_mfma_f32_32x32x4_2b_bf16 v[88:119], v[38:39], v[24:25], 0 cbsz:1 abid:0
    s_nop 15
    s_nop 2
    v_mfma_f32_32x32x16_bf16 v[88:103], v[28:31], v[16:19], v[88:103]
    v_mfma_f32_32x32x16_bf16 v[104:119], v[28:31], v[20:23], v[104:119]
    s_nop 10
    v_max3_f32 v8, v88, v89, v8
    v_max3_f32 v8, v90, v91, v8
    v_max3_f32 v8, v92, v93, v8
    v_max3_f32 v8, v94, v95, v8
    v_max3_f32 v8, v96, v97, v8
    v_max3_f32 v8, v98, v99, v8
    v_max3_f32 v8, v100, v101, v8
    v_max3_f32 v8, v102, v103, v8
    v_max3_f32 v9, v104, v105, v9
    v_max3_f32 v9, v106, v107, v9
    v_max3_f32 v9, v108, v109, v9
    v_max3_f32 v9, v110, v111, v9
    v_max3_f32 v9, v112, v113, v9
    v_max3_f32 v9, v114, v115, v9
    v_max3_f32 v9, v116, v117, v9
    v_max3_f32 v9, v118, v119, v9
    s_add_u32 s62, s62, 256
    s_sub_u32 s58, s58, 1
    s_cmp_lg_u32 s58, 0
    s_cbranch_scc1 LA_maxloop
    buffer_load_dwordx2 v[28:29], v10, s[12:15], s86 offen sc1
    s_add_u32 s63, s86, 0x4000
    buffer_load_dwordx2 v[30:31], v10, s[12:15], s63 offen sc1
    s_add_u32 s63, s86, 0x10000
    buffer_load_dwordx2 v[38:39], v11, s[12:15], s63 offen sc1
    s_branch LA_att
L_end:
    s_endpgm
.section .rodata,"a"
.p2align 6
.amdhsa_kernel gated_mix__softmax_full_mha__dense_activation_squared_relu__prompt_kernel
  .amdhsa_next_free_vgpr 256
  .amdhsa_next_free_sgpr 102
  .amdhsa_accum_offset 256
  .amdhsa_group_segment_fixed_size 0
  .amdhsa_kernarg_size 96
  .amdhsa_user_sgpr_count 2
  .amdhsa_user_sgpr_kernarg_segment_ptr 1
  .amdhsa_system_sgpr_workgroup_id_x 1
.end_amdhsa_kernel
```
